```python
import torch

def _softmax(x, axis=-1):
    return torch.softmax(x, dim=axis)
def _gelu(x):
    return torch.nn.functional.gelu(x, approximate="tanh")
def _silu(x):
    return torch.nn.functional.silu(x)
def _sigmoid(x):
    return torch.sigmoid(x)
def _layernorm(x, axis=-1, eps=1e-5):
    m = x.mean(dim=axis, keepdim=True)
    v = x.var(dim=axis, keepdim=True, unbiased=False)
    return (x - m) / torch.sqrt(v + eps)
def _scatter_add(tgt, idx, src, axis=0):
    return tgt.clone().index_add_(axis, idx, src)
def _segment_sum(src, seg, n):
    out = torch.zeros((n,) + src.shape[1:], dtype=src.dtype)
    return out.index_add_(0, seg, src)
def _pad(x, pw):
    flat = tuple(v for pair in reversed(pw) for v in pair)
    return torch.nn.functional.pad(x, flat)

kernel_name = 'gated_mix__sliding_block__dense_activation_gelu__prompt'

def setup_inputs():

    _w = (lambda a: (lambda t: t.to(torch.bfloat16) if t.is_floating_point() else t)(torch.as_tensor(a)))
    def _A_setup():
        B, S, D = 1, 2048, 448
        return {
            "x": _w((lambda *s: torch.randn(*s, dtype=torch.bfloat16) * 0.05)(B, S, D)),
            "wqkv": _w((lambda *s: torch.randn(*s, dtype=torch.bfloat16) * 0.8)(D, 3 * D)),
            "wo": _w((lambda *s: torch.randn(*s, dtype=torch.bfloat16) * 0.05)(D, D)),
        }
    _A_in = _A_setup()

    def _B_setup():
        B, S, D, F = 1, 2048, 448, 1792
        return {
            "x": _w((lambda *s: torch.randn(*s, dtype=torch.bfloat16) * 0.05)(B, S, D)),
            "w1": _w((lambda *s: torch.randn(*s, dtype=torch.bfloat16) * 12.8)(D, F) * (D ** -0.5)),
            "b1": _w((lambda *s: torch.randn(*s, dtype=torch.bfloat16) * 12.8)(F) * 0.01),
            "w2": _w((lambda *s: torch.randn(*s, dtype=torch.bfloat16) * 0.8)(F, D) * (F ** -0.5)),
            "b2": _w((lambda *s: torch.randn(*s, dtype=torch.bfloat16) * 6.4)(D) * 0.01),
        }
    _B_in = _B_setup()

    return {
        "A_x": _A_in["x"],
        "A_wqkv": _A_in["wqkv"],
        "A_wo": _A_in["wo"],
        "B_x": _B_in["x"],
        "B_w1": _B_in["w1"],
        "B_b1": _B_in["b1"],
        "B_w2": _B_in["w2"],
        "B_b2": _B_in["b2"],
        "gate_w": _w((lambda *s: torch.randn(*s, dtype=torch.bfloat16) * 0.05)(448) * 16.0),
    }

def reference(A_x, A_wqkv, A_wo, B_x, B_w1, B_b1, B_w2, B_b2, gate_w):
    def _A_ref(x, wqkv, wo):
        B, S, D = x.shape
        H = 16; Dh = D // H; W = 256
        qkv = (lambda x, *d: x.permute(*d))((x @ wqkv).reshape(B, S, 3, H, Dh), 2, 0, 3, 1, 4)
        q, k, v = qkv[0], qkv[1], qkv[2]
        scores = torch.einsum("bhqd,bhkd->bhqk", q, k) * (Dh ** -0.5)
        idx = torch.arange(S)
        mask = (idx[:, None] - idx[None, :] >= 0) & (idx[:, None] - idx[None, :] < W)
        scores = torch.where(mask[None, None], scores, -1e9)
        p = _softmax(scores, axis=-1)
        o = torch.einsum("bhqk,bhkd->bhqd", p, v)
        return (lambda x, *d: x.permute(*d))(o, 0, 2, 1, 3).reshape(B, S, D) @ wo

    def _B_ref(x, w1, b1, w2, b2):
        h = torch.einsum("bsd,df->bsf", x, w1) + b1
        h = _gelu(h)
        return torch.einsum("bsf,fd->bsd", h, w2) + b2

    x = A_x
    g = _sigmoid((x * gate_w).sum(-1, keepdims=True))
    a = _A_ref(x, A_wqkv, A_wo)
    b = _B_ref(x, B_w1, B_b1, B_w2, B_b2)
    return g * a + (1 - g) * b
```

```asm
; @launch grid=(256,1,1) block=(256,1,1) lds=163840
.amdgcn_target "amdgcn-amd-amdhsa--gfx950"
.text
.globl gated_mix__sliding_block__dense_activation_gelu__prompt_kernel
.p2align 8
.type gated_mix__sliding_block__dense_activation_gelu__prompt_kernel,@function
gated_mix__sliding_block__dense_activation_gelu__prompt_kernel:
    s_load_dwordx16 s[8:23], s[0:1], 0
    s_load_dwordx8 s[24:31], s[0:1], 64
    s_cmp_ge_u32 s2, 256
    s_cbranch_scc1 L_end
    s_getpc_b64 s[4:5]
L_pc:
    s_lshr_b32 s56, s2, 3
    v_lshrrev_b32 v1, 6, v0
    v_and_b32 v0, 63, v0
    s_and_b32 s60, s56, 7
    v_readfirstlane_b32 s48, v1
    s_mov_b32 s6, L_code_end-L_pc
    s_mov_b32 s7, 0x20000
    v_and_b32 v24, 7, v0
    v_lshl_add_u32 v24, v1, 3, v24
    v_lshlrev_b32 v24, 7, v24
    s_lshl_b32 s61, s60, 12
    buffer_load_dword v250, v24, s[4:7], 0 offen
    buffer_load_dword v251, v24, s[4:7], s61 offen
    s_lshr_b32 s61, s56, 3
    s_bfe_u32 s62, s2, 0x20001
    s_lshl_b32 s57, s62, 2
    s_add_u32 s57, s57, s61
    s_and_b32 s63, s2, 1
    s_lshl_b32 s49, s63, 3
    s_add_u32 s49, s49, s60
    s_add_u32 s60, s60, s61
    s_and_b32 s60, s60, 3
    s_lshl_b32 s60, s60, 1
    s_add_u32 s60, s60, s62
    s_add_u32 s60, s60, s63
    s_sub_u32 s61, s60, 7
    s_cmp_ge_u32 s60, 7
    s_cselect_b32 s68, s61, s60
    s_lshl_b32 s57, s57, 2
    s_add_u32 s57, s57, s48
    v_lshrrev_b32 v24, 3, v0
    s_lshl_b32 s60, s57, 5
    v_add_u32 v24, s60, v24
    v_mul_u32_u24 v24, 896, v24
    v_lshrrev_b32 v26, 4, v0
    v_and_b32 v27, 7, v0
    v_xor_b32 v26, v26, v27
    v_lshl_add_u32 v32, v26, 4, v24
    v_xor_b32 v33, 64, v32
    v_add_u32 v34, 12288, v32
    v_add_u32 v35, 18432, v33
    v_add_u32 v33, 6144, v33
    s_mul_i32 s3, s48, 12288
    s_add_u32 s82, s3, 8192
    s_add_u32 s3, s3, 106496
    s_waitcnt lgkmcnt(0)
    s_mov_b64 s[32:33], s[10:11]
    s_mov_b32 s10, 1835008
    s_mov_b32 s11, 0x20000
    s_mov_b32 m0, s3
    s_lshl_b32 s75, s68, 7
    buffer_load_dwordx4 v32, s[8:11], s75 offen lds
    buffer_load_dwordx4 v33, s[8:11], s75 offen offset:1024 lds
    buffer_load_dwordx4 v34, s[8:11], s75 offen offset:2048 lds
    buffer_load_dwordx4 v35, s[8:11], s75 offen offset:3072 lds
    s_mov_b32 s34, 1204224
    s_mov_b32 s35, 0x20000
    s_mul_i32 s60, s49, 168
    s_and_b32 s60, s60, 0xfffffff0
    s_mul_i32 s61, s48, 43008
    s_add_u32 s60, s60, s61
    s_movk_i32 s61, 2688
    v_mul_u32_u24 v26, 171, v0
    v_lshrrev_b32 v26, 11, v26
    v_mad_i32_i24 v24, v26, -12, v0
    v_min_u32 v24, 10, v24
    v_lshl_add_u32 v24, v24, 4, s60
    v_mad_u32_u24 v20, v26, s61, v24
    s_sub_u32 s60, s60, 1024
    v_add_u32 v24, 64, v0
    v_mul_u32_u24 v26, 171, v24
    v_lshrrev_b32 v26, 11, v26
    v_mad_i32_i24 v24, v26, -12, v24
    v_min_u32 v24, 10, v24
    v_lshl_add_u32 v24, v24, 4, s60
    v_mad_u32_u24 v21, v26, s61, v24
    s_sub_u32 s60, s60, 1024
    v_add_u32 v24, 128, v0
    v_mul_u32_u24 v26, 171, v24
    v_lshrrev_b32 v26, 11, v26
    v_mad_i32_i24 v24, v26, -12, v24
    v_min_u32 v24, 10, v24
    v_lshl_add_u32 v24, v24, 4, s60
    v_mad_u32_u24 v22, v26, s61, v24
    s_mul_i32 s78, s48, 3072
    s_add_u32 s78, s78, 57344
    s_mov_b32 m0, s78
    s_mul_i32 s76, s68, 172032
    buffer_load_dwordx4 v20, s[32:35], s76 offen lds
    buffer_load_dwordx4 v21, s[32:35], s76 offen offset:1024 lds
    buffer_load_dwordx4 v22, s[32:35], s76 offen offset:2048 lds
    s_add_u32 s60, s68, 1
    s_cmp_eq_u32 s60, 7
    s_cselect_b32 s69, 0, s60
    s_add_u32 s60, s69, 1
    s_cmp_eq_u32 s60, 7
    s_cselect_b32 s70, 0, s60
    s_add_u32 s60, s70, 1
    s_cmp_eq_u32 s60, 7
    s_cselect_b32 s71, 0, s60
    s_add_u32 s60, s71, 1
    s_cmp_eq_u32 s60, 7
    s_cselect_b32 s72, 0, s60
    s_add_u32 s60, s72, 1
    s_cmp_eq_u32 s60, 7
    s_cselect_b32 s73, 0, s60
    s_add_u32 s60, s73, 1
    s_cmp_eq_u32 s60, 7
    s_cselect_b32 s74, 0, s60
    s_mov_b64 s[36:37], s[18:19]
    s_mov_b64 s[40:41], s[22:23]
    s_add_u32 m0, s78, 12288
    s_mul_i32 s76, s69, 172032
    buffer_load_dwordx4 v20, s[32:35], s76 offen lds
    s_mov_b32 s38, 3584
    s_mov_b32 s39, 0x20000
    s_mov_b32 s18, 1605632
    s_mov_b32 s19, 0x20000
    s_mov_b32 s42, 896
    s_mov_b32 s43, 0x20000
    s_mov_b64 s[44:45], s[26:27]
    s_mov_b64 s[28:29], s[30:31]
    s_mov_b32 s30, 16777216
    s_mov_b32 s31, 0x20000
    s_mov_b32 s26, 896
    s_mov_b32 s27, 0x20000
    s_mov_b32 s46, 1835008
    s_mov_b32 s47, 0x20000
    s_lshr_b32 s50, 0x1248, s49
    s_and_b32 s50, s50, 1
    s_bfm_b32 s60, s49, 0
    s_and_b32 s60, s60, 0x1248
    buffer_load_dwordx4 v21, s[32:35], s76 offen offset:1024 lds
    s_bcnt1_i32_b32 s60, s60
    s_lshl_b32 s51, s49, 1
    s_sub_u32 s51, s51, s60
    s_add_u32 s52, s51, 1
    s_sub_u32 s52, s52, s50
    s_lshl_b32 s60, s48, 6
    v_add_u32 v244, s60, v0
    s_lshl_b32 s61, s68, 6
    v_add_u32 v27, s61, v244
    v_subrev_u32 v28, 448, v27
    v_min_u32 v27, v27, v28
    v_lshlrev_b32 v52, 1, v27
    v_add_u32 v27, s61, v244
    v_add_u32 v27, 256, v27
    v_subrev_u32 v28, 448, v27
    v_min_u32 v27, v27, v28
    v_lshlrev_b32 v53, 1, v27
    s_lshl_b32 s60, s51, 7
    s_cmp_eq_u32 s50, 1
    s_cselect_b32 s60, 1073741824, s60
    s_lshl_b32 s61, s52, 7
    s_sub_u32 s61, s61, 128
    s_mov_b32 s64, 0
    s_mov_b32 s65, -1
    v_mov_b32 v27, s60
    v_mov_b32 v28, s61
    v_cndmask_b32 v27, v27, v28, s[64:65]
    v_lshl_add_u32 v54, v0, 2, v27
    v_mov_b32 v55, 16252928
    v_lshlrev_b32 v1, 4, v0
    v_bfe_u32 v24, v0, 2, 2
    v_lshrrev_b32 v27, 5, v0
    v_bfe_u32 v28, v0, 4, 1
    v_and_b32 v29, 3, v0
    v_lshlrev_b32 v29, 3, v29
    v_lshl_add_u32 v29, v28, 5, v29
    v_lshl_add_u32 v40, v27, 3, v24
    v_mul_u32_u24 v41, 192, v40
    s_and_b32 s60, s49, 1
    s_lshl_b32 s60, s60, 3
    s_add_u32 s60, s60, 57344
    v_add3_u32 v6, v41, v29, s60
    v_lshrrev_b32 v41, 1, v24
    v_lshl_add_u32 v29, v41, 6, v29
    v_lshl_add_u32 v7, v40, 7, v29
    v_xor_b32 v8, 64, v7
    v_lshl_add_u32 v40, v27, 2, v24
    v_lshl_add_u32 v40, v40, 7, v29
    s_lshl_b32 s60, s48, 3
    s_lshr_b32 s60, 0x60204000, s60
    s_and_b32 s95, s60, 0xff
    v_xor_b32 v40, s95, v40
    v_add_u32 v16, s82, v40
    v_xor_b32 v17, 64, v16
    v_and_b32 v40, 31, v0
    v_bfe_u32 v41, v0, 1, 3
    v_xor_b32 v41, v41, v27
    v_lshlrev_b32 v41, 4, v41
    v_lshl_add_u32 v40, v40, 7, v41
    v_add_u32 v36, s3, v40
    v_xor_b32 v37, 32, v36
    v_xor_b32 v38, 64, v36
    v_xor_b32 v39, 96, v36
    v_lshlrev_b32 v23, 3, v27
    v_add_u32 v23, 161792, v23
    v_and_b32 v40, 3, v0
    v_lshl_add_u32 v40, v27, 2, v40
    v_bfe_u32 v41, v0, 2, 3
    v_lshl_add_u32 v40, v41, 3, v40
    v_lshlrev_b32 v11, 4, v40
    v_cmp_eq_u32 vcc, 0, v0
    v_mov_b32 v40, 1073741824
    v_mov_b32 v4, 3222493025
    v_cndmask_b32 v3, v40, 0, vcc
    s_lshl_b32 s60, s2, 2
    s_add_u32 s60, s60, s48
    s_mul_i32 s60, s60, 49
    s_lshr_b32 s96, s60, 2
    s_lshl_b32 s96, s96, 7
    s_lshr_b32 s97, s60, 4
    s_lshl_b32 s97, s97, 7
    s_mul_i32 s98, s2, 5
    s_lshr_b32 s98, s98, 8
    s_mul_i32 s99, s2, 7
    s_lshr_b32 s99, s99, 8
    s_mov_b32 s22, 1605632
    s_mov_b32 s23, 0x20000
    s_mov_b32 s14, 401408
    s_mov_b32 s15, 0x20000
    s_and_b32 s60, s2, 7
    s_and_b32 s61, s56, 1
    s_lshl_b32 s53, s60, 1
    s_add_u32 s53, s53, s61
    s_mul_i32 s61, s56, 37
    s_lshr_b32 s61, s61, 8
    s_mul_i32 s55, s61, 7
    s_sub_u32 s55, s56, s55
    s_cmp_lt_u32 s56, 28
    s_cselect_b32 s61, s61, s55
    s_lshl_b32 s54, s60, 2
    s_add_u32 s54, s54, s61
    s_lshl_b32 s54, s54, 1
    s_mul_i32 s83, s48, 401408
    s_mul_i32 s85, s54, 112
    s_mul_i32 s60, s48, 28
    s_add_u32 s85, s85, s60
    s_lshl_b32 s85, s85, 10
    s_add_u32 s85, s85, 6291456
    s_lshl_b32 s86, s54, 2
    s_add_u32 s86, s86, s48
    s_lshl_b32 s86, s86, 13
    s_add_u32 s86, s86, 13631488
    s_mul_i32 s84, s48, 100352
    s_lshl_b32 s93, s54, 7
    s_add_u32 s93, s93, 15728640
    s_lshl_b32 s60, s55, 12
    s_add_u32 s60, s60, 172032
    s_cmp_lt_u32 s56, 28
    s_cselect_b32 s60, 0, s60
    s_cselect_b32 s61, 0, 1073741824
    s_cselect_b32 s77, 7, 4
    s_cselect_b64 s[88:89], -1, 0
    s_lshl_b32 s77, s77, 12
    s_add_u32 s83, s83, s60
    s_add_u32 s85, s85, s61
    s_lshl_b32 s90, s54, 11
    s_add_u32 s90, s90, 15925248
    v_lshrrev_b32 v24, 3, v0
    v_lshlrev_b32 v28, 2, v28
    v_and_b32 v29, 7, v0
    v_xor_b32 v28, v28, v29
    v_lshlrev_b32 v28, 4, v28
    v_mul_u32_u24 v29, 3584, v24
    s_mul_i32 s60, s48, 57344
    v_add3_u32 v9, v29, v28, s60
    v_add_u32 v10, 27648, v9
    v_mul_u32_u24 v29, 896, v24
    s_lshl_b32 s60, s55, 7
    v_add3_u32 v12, v29, v28, s60
    v_add_u32 v13, 6144, v12
    v_add_u32 v14, 12288, v12
    v_add_u32 v15, 18432, v12
    v_cndmask_b32 v12, v1, v12, s[88:89]
    v_cndmask_b32 v13, v1, v13, s[88:89]
    v_cndmask_b32 v14, v1, v14, s[88:89]
    v_cndmask_b32 v15, v1, v15, s[88:89]
    s_lshl_b32 s81, s48, 11
    s_sub_u32 s79, s81, 8192
    s_add_u32 s81, s81, 106496
    s_mul_i32 s60, s49, 3
    s_sub_u32 s94, 16, s60
    s_lshl_b32 s60, s60, 6
    s_add_u32 s60, s60, s57
    s_lshl_b32 s0, s60, 11
    s_mul_i32 s61, s57, 28
    s_add_u32 s60, s61, s52
    s_lshl_b32 s60, s60, 12
    s_add_u32 s4, s60, 6291456
    s_sub_u32 s1, s4, 4096
    s_lshl_b32 s51, s51, 7
    s_lshl_b32 s52, s52, 7
    s_cmp_eq_u32 s50, 1
    s_cselect_b32 s1, 1073741824, s1
    s_cselect_b32 s51, 1073741824, s51
    s_cselect_b32 s79, 159744, s79
    s_cselect_b32 s80, 0, 8192
    s_lshl_b32 s60, s57, 4
    s_add_u32 s60, s60, s49
    buffer_load_dwordx4 v22, s[32:35], s76 offen offset:2048 lds
    s_lshl_b32 s60, s60, 7
    s_add_u32 s5, s60, 15794176
    s_lshl_b32 s60, s57, 7
    s_add_u32 s6, s60, 15728640
    s_cmp_eq_u32 s49, 3
    s_cselect_b32 s6, s6, 1073741824
    s_lshr_b32 s60, s56, 1
    s_lshl_b32 s60, s60, 2
    s_add_u32 s58, s60, s48
    s_sub_u32 s59, 8, s58
    s_max_i32 s59, s59, 0
    s_mul_i32 s61, s48, 3
    s_add_u32 s60, s60, s61
    s_sub_u32 s87, s60, 8
    s_mul_i32 s62, s53, 43
    s_lshr_b32 s62, s62, 7
    s_lshl_b32 s61, s58, 4
    s_add_u32 s62, s61, s62
    v_mov_b32 v18, s62
    s_add_u32 s62, s53, 16
    s_add_u32 m0, s3, 4096
    s_lshl_b32 s75, s69, 7
    buffer_load_dwordx4 v32, s[8:11], s75 offen lds
    s_mul_i32 s62, s62, 43
    s_lshr_b32 s62, s62, 7
    v_subrev_u32 v40, 0, v0
    v_add_u32 v41, s87, v40
    v_cmp_gt_u32 s[66:67], 3, v40
    v_cmp_le_i32 vcc, 0, v41
    v_lshl_add_u32 v41, v41, 4, s62
    s_and_b64 s[66:67], s[66:67], vcc
    v_cndmask_b32 v18, v18, v41, s[66:67]
    s_add_u32 s62, s53, 32
    s_mul_i32 s62, s62, 43
    s_lshr_b32 s62, s62, 7
    v_subrev_u32 v40, 3, v0
    v_add_u32 v41, s87, v40
    v_cmp_gt_u32 s[66:67], 3, v40
    v_cmp_le_i32 vcc, 0, v41
    v_lshl_add_u32 v41, v41, 4, s62
    s_and_b64 s[66:67], s[66:67], vcc
    buffer_load_dwordx4 v33, s[8:11], s75 offen offset:1024 lds
    v_cndmask_b32 v18, v18, v41, s[66:67]
    v_lshlrev_b32 v18, 7, v18
    v_add_u32 v18, 15794176, v18
    v_bfe_u32 v40, v0, 2, 1
    v_and_b32 v41, 3, v0
    s_lshl_b32 s60, s48, 2
    v_add_u32 v41, s60, v41
    v_cmp_gt_u32 vcc, 8, v0
    v_lshl_add_u32 v41, v40, 4, v41
    v_and_b32 v40, 1, v0
    v_lshl_add_u32 v40, v40, 4, 3
    v_cndmask_b32 v19, v40, v41, vcc
    s_sub_u32 s60, s58, s54
    buffer_load_dwordx4 v34, s[8:11], s75 offen offset:2048 lds
    s_lshl_b32 s60, s60, 4
    s_add_u32 s60, s60, 3
    v_cmp_gt_u32 vcc, 10, v0
    v_mov_b32 v40, s60
    s_nop 0
    v_cndmask_b32 v19, v40, v19, vcc
    v_lshlrev_b32 v19, 7, v19
    v_add_u32 v19, s90, v19
    s_mov_b32 s90, 0
    s_mul_i32 s60, s54, 28672
    s_lshl_b32 s61, s55, 7
    s_add_u32 s60, s60, s61
    s_add_u32 s95, s95, s60
    s_cmp_ge_u32 s49, 11
    s_cselect_b64 s[66:67], -1, 0
    s_cselect_b32 s60, 128, 0
    buffer_load_dwordx4 v35, s[8:11], s75 offen offset:3072 lds
    v_cndmask_b32 v24, v1, v11, s[66:67]
    v_xor_b32 v25, s60, v24
    s_cmp_ge_u32 s49, 10
    s_cselect_b64 s[66:67], -1, 0
    s_cselect_b32 s60, 128, 0
    v_cndmask_b32 v26, v1, v11, s[66:67]
    v_xor_b32 v27, s60, v26
    v_lshrrev_b32 v41, 5, v0
    v_bfe_u32 v42, v0, 4, 1
    v_xor_b32 v41, v41, v42
    v_bfe_u32 v40, v0, 2, 2
    v_lshl_add_u32 v40, v41, 3, v40
    v_and_b32 v41, 1, v0
    v_lshl_add_u32 v40, v41, 2, v40
    v_lshlrev_b32 v40, 4, v40
    v_lshl_add_u32 v40, v42, 10, v40
    v_bfe_u32 v41, v0, 1, 1
    v_lshl_add_u32 v40, v41, 3, v40
    s_lshl_b32 s61, s48, 11
    s_add_u32 s61, s61, 131072
    v_add_u32 v11, s61, v40
    buffer_load_dword v2, v55, s[28:31], 0 offen sc1
    buffer_load_ushort v245, v52, s[24:27], 0 offen
    buffer_load_ushort v246, v53, s[24:27], 0 offen
    s_mov_b32 m0, 163328
    s_nop 0
    buffer_load_dword v54, s[36:39], 0 offen lds
    s_lshl_b32 s61, s58, 4
    s_add_u32 s61, s61, s53
    s_lshl_b32 s24, s61, 7
    s_add_u32 s24, s24, 16056320
    s_lshl_b32 s39, s61, 11
    s_add_u32 s39, s39, 13631488
    s_lshl_b32 s60, s53, 6
    s_add_u32 s36, s60, s87
    s_lshl_b32 s36, s36, 11
    s_add_u32 s38, s60, s58
    s_lshl_b32 s38, s38, 11
    s_mul_i32 s37, s48, 6144
    s_lshl_b32 s60, s58, 7
    s_add_u32 s92, s60, 15728640
    s_mov_b32 s26, 3184710632
    s_mov_b32 s27, 3184710632
    s_waitcnt vmcnt(11)
    s_barrier
    ds_read_b128 v[144:147], v36 offset:0
    ds_read_b64_tr_b16 v[40:41], v6 offset:0
    ds_read_b64_tr_b16 v[42:43], v6 offset:768
    ds_read_b64_tr_b16 v[44:45], v6 offset:56
    ds_read_b64_tr_b16 v[46:47], v6 offset:824
    ds_read_b64_tr_b16 v[48:49], v6 offset:112
    ds_read_b64_tr_b16 v[50:51], v6 offset:880
    ds_read_b64_tr_b16 v[52:53], v6 offset:3072
    ds_read_b64_tr_b16 v[54:55], v6 offset:3840
    ds_read_b128 v[148:151], v37 offset:0
    s_waitcnt lgkmcnt(3)
    v_mfma_f32_32x32x16_bf16 v[64:79], v[40:43], v[144:147], 0
    ds_read_b64_tr_b16 v[56:57], v6 offset:3128
    ds_read_b64_tr_b16 v[58:59], v6 offset:3896
    ds_read_b128 v[152:155], v38 offset:0
    s_add_u32 m0, s78, 24576
    s_mul_i32 s76, s70, 172032
    buffer_load_dwordx4 v20, s[32:35], s76 offen lds
    v_mfma_f32_32x32x16_bf16 v[80:95], v[44:47], v[144:147], 0
    ds_read_b64_tr_b16 v[60:61], v6 offset:3184
    ds_read_b64_tr_b16 v[62:63], v6 offset:3952
    ds_read_b128 v[156:159], v39 offset:0
    buffer_load_dwordx4 v21, s[32:35], s76 offen offset:1024 lds
    v_mfma_f32_32x32x16_bf16 v[96:111], v[48:51], v[144:147], 0
    ds_read_b64_tr_b16 v[40:41], v6 offset:6144
    ds_read_b64_tr_b16 v[42:43], v6 offset:6912
    s_waitcnt lgkmcnt(3)
    v_mfma_f32_32x32x16_bf16 v[64:79], v[52:55], v[148:151], v[64:79]
    ds_read_b64_tr_b16 v[44:45], v6 offset:6200
    ds_read_b64_tr_b16 v[46:47], v6 offset:6968
    buffer_load_dwordx4 v22, s[32:35], s76 offen offset:2048 lds
    v_mfma_f32_32x32x16_bf16 v[80:95], v[56:59], v[148:151], v[80:95]
    ds_read_b64_tr_b16 v[48:49], v6 offset:6256
    ds_read_b64_tr_b16 v[50:51], v6 offset:7024
    s_add_u32 m0, s3, 8192
    s_lshl_b32 s75, s70, 7
    buffer_load_dwordx4 v32, s[8:11], s75 offen lds
    v_mfma_f32_32x32x16_bf16 v[96:111], v[60:63], v[148:151], v[96:111]
    ds_read_b64_tr_b16 v[52:53], v6 offset:9216
    ds_read_b64_tr_b16 v[54:55], v6 offset:9984
    s_waitcnt lgkmcnt(2)
    v_mfma_f32_32x32x16_bf16 v[64:79], v[40:43], v[152:155], v[64:79]
    ds_read_b64_tr_b16 v[56:57], v6 offset:9272
    ds_read_b64_tr_b16 v[58:59], v6 offset:10040
    buffer_load_dwordx4 v33, s[8:11], s75 offen offset:1024 lds
    v_mfma_f32_32x32x16_bf16 v[80:95], v[44:47], v[152:155], v[80:95]
    ds_read_b64_tr_b16 v[60:61], v6 offset:9328
    ds_read_b64_tr_b16 v[62:63], v6 offset:10096
    buffer_load_dwordx4 v34, s[8:11], s75 offen offset:2048 lds
    v_mfma_f32_32x32x16_bf16 v[96:111], v[48:51], v[152:155], v[96:111]
    buffer_load_dwordx4 v35, s[8:11], s75 offen offset:3072 lds
    s_waitcnt vmcnt(11)
    s_barrier
    ds_read_b64_tr_b16 v[40:41], v6 offset:12288
    ds_read_b64_tr_b16 v[42:43], v6 offset:13056
    ds_read_b128 v[160:163], v36 offset:4096
    s_add_u32 m0, s78, 36864
    s_mul_i32 s76, s71, 172032
    buffer_load_dwordx4 v20, s[32:35], s76 offen lds
    s_waitcnt lgkmcnt(3)
    v_mfma_f32_32x32x16_bf16 v[64:79], v[52:55], v[156:159], v[64:79]
    ds_read_b64_tr_b16 v[44:45], v6 offset:12344
    ds_read_b64_tr_b16 v[46:47], v6 offset:13112
    ds_read_b128 v[164:167], v37 offset:4096
    buffer_load_dwordx4 v21, s[32:35], s76 offen offset:1024 lds
    v_mfma_f32_32x32x16_bf16 v[80:95], v[56:59], v[156:159], v[80:95]
    ds_read_b64_tr_b16 v[48:49], v6 offset:12400
    ds_read_b64_tr_b16 v[50:51], v6 offset:13168
    ds_read_b128 v[168:171], v38 offset:4096
    v_mfma_f32_32x32x16_bf16 v[96:111], v[60:63], v[156:159], v[96:111]
    ds_read_b64_tr_b16 v[52:53], v6 offset:15360
    ds_read_b64_tr_b16 v[54:55], v6 offset:16128
    ds_read_b128 v[172:175], v39 offset:4096
    buffer_load_dwordx4 v22, s[32:35], s76 offen offset:2048 lds
    s_cmp_eq_u32 s98, 0
    s_cbranch_scc1 L_pf1
L_pfb1:
    s_waitcnt lgkmcnt(4)
    v_mfma_f32_32x32x16_bf16 v[64:79], v[40:43], v[160:163], v[64:79]
    ds_read_b64_tr_b16 v[56:57], v6 offset:15416
    ds_read_b64_tr_b16 v[58:59], v6 offset:16184
    v_mfma_f32_32x32x16_bf16 v[80:95], v[44:47], v[160:163], v[80:95]
    ds_read_b64_tr_b16 v[60:61], v6 offset:15472
    ds_read_b64_tr_b16 v[62:63], v6 offset:16240
    s_mov_b32 m0, s3
    s_lshl_b32 s75, s71, 7
    buffer_load_dwordx4 v32, s[8:11], s75 offen lds
    v_mfma_f32_32x32x16_bf16 v[96:111], v[48:51], v[160:163], v[96:111]
    ds_read_b64_tr_b16 v[40:41], v6 offset:18432
    ds_read_b64_tr_b16 v[42:43], v6 offset:19200
    s_waitcnt lgkmcnt(2)
    v_mfma_f32_32x32x16_bf16 v[64:79], v[52:55], v[164:167], v[64:79]
    ds_read_b64_tr_b16 v[44:45], v6 offset:18488
    ds_read_b64_tr_b16 v[46:47], v6 offset:19256
    buffer_load_dwordx4 v33, s[8:11], s75 offen offset:1024 lds
    v_mfma_f32_32x32x16_bf16 v[80:95], v[56:59], v[164:167], v[80:95]
    ds_read_b64_tr_b16 v[48:49], v6 offset:18544
    ds_read_b64_tr_b16 v[50:51], v6 offset:19312
    buffer_load_dwordx4 v34, s[8:11], s75 offen offset:2048 lds
    v_mfma_f32_32x32x16_bf16 v[96:111], v[60:63], v[164:167], v[96:111]
    ds_read_b64_tr_b16 v[52:53], v6 offset:21504
    ds_read_b64_tr_b16 v[54:55], v6 offset:22272
    buffer_load_dwordx4 v35, s[8:11], s75 offen offset:3072 lds
    s_cmp_eq_u32 s98, 1
    s_cbranch_scc1 L_pf2
L_pfb2:
    s_waitcnt lgkmcnt(2)
    v_mfma_f32_32x32x16_bf16 v[64:79], v[40:43], v[168:171], v[64:79]
    ds_read_b64_tr_b16 v[56:57], v6 offset:21560
    ds_read_b64_tr_b16 v[58:59], v6 offset:22328
    v_mfma_f32_32x32x16_bf16 v[80:95], v[44:47], v[168:171], v[80:95]
    ds_read_b64_tr_b16 v[60:61], v6 offset:21616
    ds_read_b64_tr_b16 v[62:63], v6 offset:22384
    v_mfma_f32_32x32x16_bf16 v[96:111], v[48:51], v[168:171], v[96:111]
    s_waitcnt vmcnt(7)
    s_barrier
    ds_read_b64_tr_b16 v[40:41], v6 offset:24576
    ds_read_b64_tr_b16 v[42:43], v6 offset:25344
    ds_read_b128 v[176:179], v36 offset:8192
    s_mov_b32 m0, s78
    s_mul_i32 s76, s72, 172032
    buffer_load_dwordx4 v20, s[32:35], s76 offen lds
    s_waitcnt lgkmcnt(3)
    v_mfma_f32_32x32x16_bf16 v[64:79], v[52:55], v[172:175], v[64:79]
    ds_read_b64_tr_b16 v[44:45], v6 offset:24632
    ds_read_b64_tr_b16 v[46:47], v6 offset:25400
    ds_read_b128 v[180:183], v37 offset:8192
    buffer_load_dwordx4 v21, s[32:35], s76 offen offset:1024 lds
    v_mfma_f32_32x32x16_bf16 v[80:95], v[56:59], v[172:175], v[80:95]
    ds_read_b64_tr_b16 v[48:49], v6 offset:24688
    ds_read_b64_tr_b16 v[50:51], v6 offset:25456
    ds_read_b128 v[184:187], v38 offset:8192
    v_mfma_f32_32x32x16_bf16 v[96:111], v[60:63], v[172:175], v[96:111]
    ds_read_b64_tr_b16 v[52:53], v6 offset:27648
    ds_read_b64_tr_b16 v[54:55], v6 offset:28416
    ds_read_b128 v[188:191], v39 offset:8192
    buffer_load_dwordx4 v22, s[32:35], s76 offen offset:2048 lds
    s_cmp_eq_u32 s98, 2
    s_cbranch_scc1 L_pf3
L_pfb3:
    s_waitcnt lgkmcnt(4)
    v_mfma_f32_32x32x16_bf16 v[64:79], v[40:43], v[176:179], v[64:79]
    ds_read_b64_tr_b16 v[56:57], v6 offset:27704
    ds_read_b64_tr_b16 v[58:59], v6 offset:28472
    s_add_u32 m0, s3, 4096
    s_lshl_b32 s75, s72, 7
    buffer_load_dwordx4 v32, s[8:11], s75 offen lds
    v_mfma_f32_32x32x16_bf16 v[80:95], v[44:47], v[176:179], v[80:95]
    ds_read_b64_tr_b16 v[60:61], v6 offset:27760
    ds_read_b64_tr_b16 v[62:63], v6 offset:28528
    v_add_u32 v2, 1799596471, v2
    s_cmp_eq_u32 s50, 1
    s_cselect_b64 s[66:67], -1, 0
    v_mfma_f32_32x32x16_bf16 v[96:111], v[48:51], v[176:179], v[96:111]
    ds_read_b64_tr_b16 v[40:41], v6 offset:30720
    ds_read_b64_tr_b16 v[42:43], v6 offset:31488
    buffer_load_dwordx4 v33, s[8:11], s75 offen offset:1024 lds
    v_bfe_u32 v247, v244, 1, 1
    s_waitcnt lgkmcnt(2)
    v_mfma_f32_32x32x16_bf16 v[64:79], v[52:55], v[180:183], v[64:79]
    ds_read_b64_tr_b16 v[44:45], v6 offset:30776
    ds_read_b64_tr_b16 v[46:47], v6 offset:31544
    buffer_load_dwordx4 v34, s[8:11], s75 offen offset:2048 lds
    v_lshlrev_b32 v248, 7, v244
    v_mfma_f32_32x32x16_bf16 v[80:95], v[56:59], v[180:183], v[80:95]
    ds_read_b64_tr_b16 v[48:49], v6 offset:30832
    ds_read_b64_tr_b16 v[50:51], v6 offset:31600
    buffer_load_dwordx4 v35, s[8:11], s75 offen offset:3072 lds
    v_lshl_add_u32 v248, v247, 6, v248
    v_mfma_f32_32x32x16_bf16 v[96:111], v[60:63], v[180:183], v[96:111]
    ds_read_b64_tr_b16 v[52:53], v6 offset:33792
    ds_read_b64_tr_b16 v[54:55], v6 offset:34560
    v_mov_b32 v249, 161792
    v_cndmask_b32 v247, v249, v248, s[66:67]
    v_cmp_gt_u32 vcc, 192, v244
    s_cmp_eq_u32 s98, 3
    s_cbranch_scc1 L_pf4
L_pfb4:
    s_waitcnt lgkmcnt(2)
    v_mfma_f32_32x32x16_bf16 v[64:79], v[40:43], v[184:187], v[64:79]
    ds_read_b64_tr_b16 v[56:57], v6 offset:33848
    ds_read_b64_tr_b16 v[58:59], v6 offset:34616
    v_add_u32 v248, 32768, v248
    s_and_b64 s[66:67], s[66:67], vcc
    ds_write_b16 v247, v245
    v_mfma_f32_32x32x16_bf16 v[80:95], v[44:47], v[184:187], v[80:95]
    ds_read_b64_tr_b16 v[60:61], v6 offset:33904
    ds_read_b64_tr_b16 v[62:63], v6 offset:34672
    v_cndmask_b32 v248, v249, v248, s[66:67]
    ds_write_b16 v248, v246
    ds_read2_b64 v[120:123], v23 offset0:192 offset1:194
    v_mfma_f32_32x32x16_bf16 v[96:111], v[48:51], v[184:187], v[96:111]
    s_waitcnt vmcnt(7)
    s_barrier
    ds_read_b64_tr_b16 v[40:41], v6 offset:36864
    ds_read_b64_tr_b16 v[42:43], v6 offset:37632
    ds_read_b128 v[192:195], v36 offset:0
    s_add_u32 m0, s78, 12288
    s_mul_i32 s76, s73, 172032
    buffer_load_dwordx4 v20, s[32:35], s76 offen lds
    s_waitcnt lgkmcnt(5)
    v_mfma_f32_32x32x16_bf16 v[64:79], v[52:55], v[188:191], v[64:79]
    ds_read_b64_tr_b16 v[44:45], v6 offset:36920
    ds_read_b64_tr_b16 v[46:47], v6 offset:37688
    ds_read_b128 v[196:199], v37 offset:0
    buffer_load_dwordx4 v21, s[32:35], s76 offen offset:1024 lds
    v_mfma_f32_32x32x16_bf16 v[80:95], v[56:59], v[188:191], v[80:95]
    ds_read_b64_tr_b16 v[48:49], v6 offset:36976
    ds_read_b64_tr_b16 v[50:51], v6 offset:37744
    ds_read_b128 v[200:203], v38 offset:0
    ds_read2_b64 v[124:127], v23 offset0:196 offset1:198
    ds_read2_b64 v[136:139], v23 offset0:200 offset1:202
    v_mfma_f32_32x32x16_bf16 v[96:111], v[60:63], v[188:191], v[96:111]
    ds_read_b64_tr_b16 v[52:53], v6 offset:39936
    ds_read_b64_tr_b16 v[54:55], v6 offset:40704
    ds_read_b128 v[204:207], v39 offset:0
    buffer_load_dwordx4 v22, s[32:35], s76 offen offset:2048 lds
    s_cmp_eq_u32 s98, 4
    s_cbranch_scc1 L_pf5
L_pfb5:
    s_waitcnt lgkmcnt(6)
    v_mfma_f32_32x32x16_bf16 v[64:79], v[40:43], v[192:195], v[64:79]
    ds_read_b64_tr_b16 v[56:57], v6 offset:39992
    ds_read_b64_tr_b16 v[58:59], v6 offset:40760
    s_add_u32 m0, s3, 8192
    s_lshl_b32 s75, s73, 7
    buffer_load_dwordx4 v32, s[8:11], s75 offen lds
    v_mfma_f32_32x32x16_bf16 v[80:95], v[44:47], v[192:195], v[80:95]
    ds_read_b64_tr_b16 v[60:61], v6 offset:40048
    ds_read_b64_tr_b16 v[62:63], v6 offset:40816
    ds_read2_b64 v[140:143], v23 offset0:204 offset1:206
    v_lshlrev_b32 v112, 16, v120
    v_and_b32 v113, 0xffff0000, v120
    v_mfma_f32_32x32x16_bf16 v[96:111], v[48:51], v[192:195], v[96:111]
    ds_read_b64_tr_b16 v[40:41], v6 offset:43008
    ds_read_b64_tr_b16 v[42:43], v6 offset:43776
    buffer_load_dwordx4 v33, s[8:11], s75 offen offset:1024 lds
    v_lshlrev_b32 v114, 16, v121
    s_waitcnt lgkmcnt(3)
    v_mfma_f32_32x32x16_bf16 v[64:79], v[52:55], v[196:199], v[64:79]
    ds_read_b64_tr_b16 v[44:45], v6 offset:43064
    ds_read_b64_tr_b16 v[46:47], v6 offset:43832
    buffer_load_dwordx4 v34, s[8:11], s75 offen offset:2048 lds
    v_and_b32 v115, 0xffff0000, v121
    v_mfma_f32_32x32x16_bf16 v[80:95], v[56:59], v[196:199], v[80:95]
    ds_read_b64_tr_b16 v[48:49], v6 offset:43120
    ds_read_b64_tr_b16 v[50:51], v6 offset:43888
    buffer_load_dwordx4 v35, s[8:11], s75 offen offset:3072 lds
    v_lshlrev_b32 v116, 16, v122
    v_mfma_f32_32x32x16_bf16 v[96:111], v[60:63], v[196:199], v[96:111]
    ds_read_b64_tr_b16 v[52:53], v6 offset:46080
    ds_read_b64_tr_b16 v[54:55], v6 offset:46848
    v_and_b32 v117, 0xffff0000, v122
    v_lshlrev_b32 v118, 16, v123
    v_and_b32 v119, 0xffff0000, v123
    s_cmp_eq_u32 s99, 0
    s_cbranch_scc1 L_pf6
L_pfb6:
    s_waitcnt lgkmcnt(2)
    v_mfma_f32_32x32x16_bf16 v[64:79], v[40:43], v[200:203], v[64:79]
    ds_read_b64_tr_b16 v[56:57], v6 offset:46136
    ds_read_b64_tr_b16 v[58:59], v6 offset:46904
    v_lshlrev_b32 v120, 16, v124
    v_and_b32 v121, 0xffff0000, v124
    v_lshlrev_b32 v122, 16, v125
    v_mfma_f32_32x32x16_bf16 v[80:95], v[44:47], v[200:203], v[80:95]
    ds_read_b64_tr_b16 v[60:61], v6 offset:46192
    ds_read_b64_tr_b16 v[62:63], v6 offset:46960
    v_and_b32 v123, 0xffff0000, v125
    v_lshlrev_b32 v124, 16, v126
    v_and_b32 v125, 0xffff0000, v126
    v_mfma_f32_32x32x16_bf16 v[96:111], v[48:51], v[200:203], v[96:111]
    s_waitcnt vmcnt(7)
    s_barrier
    s_cmp_eq_u32 s80, 0
    s_cbranch_scc1 L_light
    ds_read_b64_tr_b16 v[40:41], v6 offset:0
    ds_read_b64_tr_b16 v[42:43], v6 offset:768
    ds_read_b128 v[208:211], v36 offset:4096
    s_add_u32 m0, s78, 24576
    s_mul_i32 s76, s74, 172032
    buffer_load_dwordx4 v20, s[32:35], s76 offen lds
    s_waitcnt lgkmcnt(3)
    v_mfma_f32_32x32x16_bf16 v[64:79], v[52:55], v[204:207], v[64:79]
    ds_read_b64_tr_b16 v[44:45], v6 offset:56
    ds_read_b64_tr_b16 v[46:47], v6 offset:824
    ds_read_b128 v[212:215], v37 offset:4096
    buffer_load_dwordx4 v21, s[32:35], s76 offen offset:1024 lds
    v_mfma_f32_32x32x16_bf16 v[80:95], v[56:59], v[204:207], v[80:95]
    ds_read_b64_tr_b16 v[48:49], v6 offset:112
    ds_read_b64_tr_b16 v[50:51], v6 offset:880
    ds_read_b128 v[216:219], v38 offset:4096
    v_lshlrev_b32 v126, 16, v127
    v_and_b32 v127, 0xffff0000, v127
    v_mfma_f32_32x32x16_bf16 v[96:111], v[60:63], v[204:207], v[96:111]
    ds_read_b64_tr_b16 v[52:53], v6 offset:3072
    ds_read_b64_tr_b16 v[54:55], v6 offset:3840
    ds_read_b128 v[220:223], v39 offset:4096
    buffer_load_dwordx4 v22, s[32:35], s76 offen offset:2048 lds
    s_cmp_eq_u32 s99, 1
    s_cbranch_scc1 L_pf7
L_pfb7:
    s_waitcnt lgkmcnt(4)
    v_mfma_f32_32x32x16_bf16 v[64:79], v[40:43], v[208:211], v[64:79]
    ds_read_b64_tr_b16 v[56:57], v6 offset:3128
    ds_read_b64_tr_b16 v[58:59], v6 offset:3896
    s_mov_b32 m0, s3
    s_lshl_b32 s75, s74, 7
    buffer_load_dwordx4 v32, s[8:11], s75 offen lds
    v_mfma_f32_32x32x16_bf16 v[80:95], v[44:47], v[208:211], v[80:95]
    ds_read_b64_tr_b16 v[60:61], v6 offset:3184
    ds_read_b64_tr_b16 v[62:63], v6 offset:3952
    v_lshlrev_b32 v128, 16, v136
    v_and_b32 v129, 0xffff0000, v136
    v_lshlrev_b32 v130, 16, v137
    v_mfma_f32_32x32x16_bf16 v[96:111], v[48:51], v[208:211], v[96:111]
    ds_read_b64_tr_b16 v[40:41], v6 offset:6144
    ds_read_b64_tr_b16 v[42:43], v6 offset:6912
    buffer_load_dwordx4 v33, s[8:11], s75 offen offset:1024 lds
    v_and_b32 v131, 0xffff0000, v137
    s_waitcnt lgkmcnt(2)
    v_mfma_f32_32x32x16_bf16 v[64:79], v[52:55], v[212:215], v[64:79]
    ds_read_b64_tr_b16 v[44:45], v6 offset:6200
    ds_read_b64_tr_b16 v[46:47], v6 offset:6968
    buffer_load_dwordx4 v34, s[8:11], s75 offen offset:2048 lds
    v_lshlrev_b32 v132, 16, v138
    v_mfma_f32_32x32x16_bf16 v[80:95], v[56:59], v[212:215], v[80:95]
    ds_read_b64_tr_b16 v[48:49], v6 offset:6256
    ds_read_b64_tr_b16 v[50:51], v6 offset:7024
    buffer_load_dwordx4 v35, s[8:11], s75 offen offset:3072 lds
    v_and_b32 v133, 0xffff0000, v138
    v_mfma_f32_32x32x16_bf16 v[96:111], v[60:63], v[212:215], v[96:111]
    ds_read_b64_tr_b16 v[52:53], v6 offset:9216
    ds_read_b64_tr_b16 v[54:55], v6 offset:9984
    v_lshlrev_b32 v134, 16, v139
    v_and_b32 v135, 0xffff0000, v139
    v_lshlrev_b32 v136, 16, v140
    s_cmp_eq_u32 s99, 2
    s_cbranch_scc1 L_pf8
L_pfb8:
    s_waitcnt lgkmcnt(2)
    v_mfma_f32_32x32x16_bf16 v[64:79], v[40:43], v[216:219], v[64:79]
    ds_read_b64_tr_b16 v[56:57], v6 offset:9272
    ds_read_b64_tr_b16 v[58:59], v6 offset:10040
    s_add_u32 s79, s79, s80
    s_mov_b32 m0, s79
    s_mul_i32 s76, s68, 229376
    s_add_u32 s76, s76, s51
    buffer_load_dwordx4 v9, s[16:19], s76 offen lds
    v_mfma_f32_32x32x16_bf16 v[80:95], v[44:47], v[216:219], v[80:95]
    ds_read_b64_tr_b16 v[60:61], v6 offset:9328
    ds_read_b64_tr_b16 v[62:63], v6 offset:10096
    buffer_load_dwordx4 v10, s[16:19], s76 offen offset:1024 lds
    v_and_b32 v137, 0xffff0000, v140
    v_mfma_f32_32x32x16_bf16 v[96:111], v[48:51], v[216:219], v[96:111]
    s_waitcnt vmcnt(9)
    s_barrier
    ds_read_b64_tr_b16 v[40:41], v6 offset:12288
    ds_read_b64_tr_b16 v[42:43], v6 offset:13056
    ds_read_b128 v[224:227], v36 offset:8192
    s_add_u32 s79, s79, s80
    s_mov_b32 m0, s79
    s_mul_i32 s76, s69, 229376
    s_add_u32 s76, s76, s51
    buffer_load_dwordx4 v9, s[16:19], s76 offen lds
    s_waitcnt lgkmcnt(3)
    v_mfma_f32_32x32x16_bf16 v[64:79], v[52:55], v[220:223], v[64:79]
    ds_read_b64_tr_b16 v[44:45], v6 offset:12344
    ds_read_b64_tr_b16 v[46:47], v6 offset:13112
    ds_read_b128 v[228:231], v37 offset:8192
    buffer_load_dwordx4 v10, s[16:19], s76 offen offset:1024 lds
    v_mfma_f32_32x32x16_bf16 v[80:95], v[56:59], v[220:223], v[80:95]
    ds_read_b64_tr_b16 v[48:49], v6 offset:12400
    ds_read_b64_tr_b16 v[50:51], v6 offset:13168
    ds_read_b128 v[232:235], v38 offset:8192
    s_add_u32 s79, s79, s80
    s_mov_b32 m0, s79
    s_mul_i32 s76, s70, 229376
    s_add_u32 s76, s76, s51
    buffer_load_dwordx4 v9, s[16:19], s76 offen lds
    v_mfma_f32_32x32x16_bf16 v[96:111], v[60:63], v[220:223], v[96:111]
    ds_read_b64_tr_b16 v[52:53], v6 offset:15360
    ds_read_b64_tr_b16 v[54:55], v6 offset:16128
    ds_read_b128 v[236:239], v39 offset:8192
    buffer_load_dwordx4 v10, s[16:19], s76 offen offset:1024 lds
    s_cmp_eq_u32 s99, 3
    s_cbranch_scc1 L_pf9
L_pfb9:
    s_waitcnt lgkmcnt(4)
    v_mfma_f32_32x32x16_bf16 v[64:79], v[40:43], v[224:227], v[64:79]
    ds_read_b64_tr_b16 v[56:57], v6 offset:15416
    ds_read_b64_tr_b16 v[58:59], v6 offset:16184
    v_lshlrev_b32 v138, 16, v141
    v_and_b32 v139, 0xffff0000, v141
    v_lshlrev_b32 v140, 16, v142
    v_mfma_f32_32x32x16_bf16 v[80:95], v[44:47], v[224:227], v[80:95]
    ds_read_b64_tr_b16 v[60:61], v6 offset:15472
    ds_read_b64_tr_b16 v[62:63], v6 offset:16240
    s_add_u32 s79, s79, s80
    s_mov_b32 m0, s79
    s_mul_i32 s76, s71, 229376
    s_add_u32 s76, s76, s51
    buffer_load_dwordx4 v9, s[16:19], s76 offen lds
    v_mfma_f32_32x32x16_bf16 v[96:111], v[48:51], v[224:227], v[96:111]
    ds_read_b64_tr_b16 v[40:41], v6 offset:18432
    ds_read_b64_tr_b16 v[42:43], v6 offset:19200
    buffer_load_dwordx4 v10, s[16:19], s76 offen offset:1024 lds
    v_and_b32 v141, 0xffff0000, v142
    s_waitcnt lgkmcnt(2)
    v_mfma_f32_32x32x16_bf16 v[64:79], v[52:55], v[228:231], v[64:79]
    ds_read_b64_tr_b16 v[44:45], v6 offset:18488
    ds_read_b64_tr_b16 v[46:47], v6 offset:19256
    s_add_u32 s79, s79, s80
    s_mov_b32 m0, s79
    s_mul_i32 s76, s72, 229376
    s_add_u32 s76, s76, s51
    buffer_load_dwordx4 v9, s[16:19], s76 offen lds
    v_mfma_f32_32x32x16_bf16 v[80:95], v[56:59], v[228:231], v[80:95]
    ds_read_b64_tr_b16 v[48:49], v6 offset:18544
    ds_read_b64_tr_b16 v[50:51], v6 offset:19312
    v_lshlrev_b32 v142, 16, v143
    v_and_b32 v143, 0xffff0000, v143
    v_mfma_f32_32x32x16_bf16 v[96:111], v[60:63], v[228:231], v[96:111]
    ds_read_b64_tr_b16 v[52:53], v6 offset:21504
    ds_read_b64_tr_b16 v[54:55], v6 offset:22272
    s_cmp_eq_u32 s99, 4
    s_cbranch_scc1 L_pf10
L_pfb10:
    s_waitcnt lgkmcnt(2)
    v_mfma_f32_32x32x16_bf16 v[64:79], v[40:43], v[232:235], v[64:79]
    ds_read_b64_tr_b16 v[56:57], v6 offset:21560
    ds_read_b64_tr_b16 v[58:59], v6 offset:22328
    buffer_load_dwordx4 v10, s[16:19], s76 offen offset:1024 lds
    v_mfma_f32_32x32x16_bf16 v[80:95], v[44:47], v[232:235], v[80:95]
    ds_read_b64_tr_b16 v[60:61], v6 offset:21616
    ds_read_b64_tr_b16 v[62:63], v6 offset:22384
    s_add_u32 s79, s79, s80
    s_mov_b32 m0, s79
    s_mul_i32 s76, s73, 229376
    s_add_u32 s76, s76, s51
    buffer_load_dwordx4 v9, s[16:19], s76 offen lds
    v_mfma_f32_32x32x16_bf16 v[96:111], v[48:51], v[232:235], v[96:111]
    s_waitcnt vmcnt(11)
    s_barrier
    ds_read_b64_tr_b16 v[40:41], v6 offset:24576
    ds_read_b64_tr_b16 v[42:43], v6 offset:25344
    ds_read_b128 v[240:243], v36 offset:0
    buffer_load_dwordx4 v10, s[16:19], s76 offen offset:1024 lds
    s_waitcnt lgkmcnt(3)
    v_mfma_f32_32x32x16_bf16 v[64:79], v[52:55], v[236:239], v[64:79]
    ds_read_b64_tr_b16 v[44:45], v6 offset:24632
    ds_read_b64_tr_b16 v[46:47], v6 offset:25400
    ds_read_b128 v[244:247], v37 offset:0
    s_add_u32 s79, s79, s80
    s_mov_b32 m0, s79
    s_mul_i32 s76, s74, 229376
    s_add_u32 s76, s76, s51
    buffer_load_dwordx4 v9, s[16:19], s76 offen lds
    v_mfma_f32_32x32x16_bf16 v[80:95], v[56:59], v[236:239], v[80:95]
    ds_read_b64_tr_b16 v[48:49], v6 offset:24688
    ds_read_b64_tr_b16 v[50:51], v6 offset:25456
    ds_read_b128 v[248:251], v38 offset:0
    v_mfma_f32_32x32x16_bf16 v[96:111], v[60:63], v[236:239], v[96:111]
    ds_read_b64_tr_b16 v[52:53], v6 offset:27648
    ds_read_b64_tr_b16 v[54:55], v6 offset:28416
    ds_read_b128 v[252:255], v39 offset:0
    buffer_load_dwordx4 v10, s[16:19], s76 offen offset:1024 lds
    s_cmp_eq_u32 s99, 5
    s_cbranch_scc1 L_pf11
L_pfb11:
    s_waitcnt lgkmcnt(4)
    v_mfma_f32_32x32x16_bf16 v[64:79], v[40:43], v[240:243], v[64:79]
    ds_read_b64_tr_b16 v[56:57], v6 offset:27704
    ds_read_b64_tr_b16 v[58:59], v6 offset:28472
    v_mfma_f32_32x32x16_bf16 v[80:95], v[44:47], v[240:243], v[80:95]
    ds_read_b64_tr_b16 v[60:61], v6 offset:27760
    ds_read_b64_tr_b16 v[62:63], v6 offset:28528
    v_mfma_f32_32x32x16_bf16 v[96:111], v[48:51], v[240:243], v[96:111]
    ds_read_b64_tr_b16 v[40:41], v6 offset:30720
    ds_read_b64_tr_b16 v[42:43], v6 offset:31488
    s_waitcnt lgkmcnt(2)
    v_mfma_f32_32x32x16_bf16 v[64:79], v[52:55], v[244:247], v[64:79]
    ds_read_b64_tr_b16 v[44:45], v6 offset:30776
    ds_read_b64_tr_b16 v[46:47], v6 offset:31544
    v_mfma_f32_32x32x16_bf16 v[80:95], v[56:59], v[244:247], v[80:95]
    ds_read_b64_tr_b16 v[48:49], v6 offset:30832
    ds_read_b64_tr_b16 v[50:51], v6 offset:31600
    v_mfma_f32_32x32x16_bf16 v[96:111], v[60:63], v[244:247], v[96:111]
    ds_read_b64_tr_b16 v[52:53], v6 offset:33792
    ds_read_b64_tr_b16 v[54:55], v6 offset:34560
    s_cmp_eq_u32 s99, 6
    s_cbranch_scc1 L_pf12
L_pfb12:
    s_waitcnt lgkmcnt(2)
    v_mfma_f32_32x32x16_bf16 v[64:79], v[40:43], v[248:251], v[64:79]
    ds_read_b64_tr_b16 v[56:57], v6 offset:33848
    ds_read_b64_tr_b16 v[58:59], v6 offset:34616
    v_mfma_f32_32x32x16_bf16 v[80:95], v[44:47], v[248:251], v[80:95]
    ds_read_b64_tr_b16 v[60:61], v6 offset:33904
    ds_read_b64_tr_b16 v[62:63], v6 offset:34672
    v_mfma_f32_32x32x16_bf16 v[96:111], v[48:51], v[248:251], v[96:111]
    s_waitcnt vmcnt(8)
    s_waitcnt lgkmcnt(0)
    s_barrier
    ds_read_b64_tr_b16 v[40:41], v7 offset:0
    ds_read_b64_tr_b16 v[42:43], v7 offset:512
    v_mfma_f32_32x32x16_bf16 v[64:79], v[52:55], v[252:255], v[64:79]
    ds_read_b64_tr_b16 v[44:45], v8 offset:0
    ds_read_b64_tr_b16 v[46:47], v8 offset:512
    v_mfma_f32_32x32x16_bf16 v[80:95], v[56:59], v[252:255], v[80:95]
    ds_read_b64_tr_b16 v[48:49], v7 offset:2048
    ds_read_b64_tr_b16 v[50:51], v7 offset:2560
    v_mfma_f32_32x32x16_bf16 v[96:111], v[60:63], v[252:255], v[96:111]
    ds_read_b64_tr_b16 v[52:53], v8 offset:2048
    ds_read_b64_tr_b16 v[54:55], v8 offset:2560
    s_cmp_lt_u32 s56, 28
    s_cselect_b32 s22, 1605632, 0
    s_cselect_b32 s14, 401408, 0
    s_waitcnt lgkmcnt(4)
    v_mfma_f32_32x32x16_bf16 v[112:127], v[40:43], v[144:147], v[112:127]
    ds_read_b64_tr_b16 v[56:57], v7 offset:4096
    ds_read_b64_tr_b16 v[58:59], v7 offset:4608
    s_mov_b32 m0, s81
    s_mul_i32 s76, s68, 229376
    s_add_u32 s76, s76, s52
    buffer_load_dwordx4 v9, s[16:19], s76 offen lds
    v_mfma_f32_32x32x16_bf16 v[128:143], v[44:47], v[144:147], v[128:143]
    ds_read_b64_tr_b16 v[60:61], v8 offset:4096
    ds_read_b64_tr_b16 v[62:63], v8 offset:4608
    buffer_load_dwordx4 v10, s[16:19], s76 offen offset:1024 lds
    s_movk_i32 s63, 0x3f80
    s_waitcnt lgkmcnt(4)
    v_mfma_f32_32x32x16_bf16 v[112:127], v[48:51], v[148:151], v[112:127]
    ds_read_b64_tr_b16 v[40:41], v7 offset:6144
    ds_read_b64_tr_b16 v[42:43], v7 offset:6656
    s_add_u32 m0, s81, 8192
    s_mul_i32 s76, s69, 229376
    s_add_u32 s76, s76, s52
    buffer_load_dwordx4 v9, s[16:19], s76 offen lds
    v_mfma_f32_32x32x16_bf16 v[128:143], v[52:55], v[148:151], v[128:143]
    ds_read_b64_tr_b16 v[44:45], v8 offset:6144
    ds_read_b64_tr_b16 v[46:47], v8 offset:6656
    buffer_load_dwordx4 v10, s[16:19], s76 offen offset:1024 lds
    s_waitcnt lgkmcnt(4)
    v_mfma_f32_32x32x16_bf16 v[112:127], v[56:59], v[152:155], v[112:127]
    ds_read_b64_tr_b16 v[48:49], v7 offset:8192
    ds_read_b64_tr_b16 v[50:51], v7 offset:8704
    s_cmp_gt_i32 s94, -14
    s_cselect_b32 s60, 0x3f803f80, s63
    s_cselect_b32 s62, s63, 0
    v_mfma_f32_32x32x16_bf16 v[128:143], v[60:63], v[152:155], v[128:143]
    ds_read_b64_tr_b16 v[52:53], v8 offset:8192
    ds_read_b64_tr_b16 v[54:55], v8 offset:8704
    s_add_u32 m0, s82, 49152
    s_nop 0
    buffer_load_dwordx4 v12, s[20:23], s83 offen lds
    s_waitcnt lgkmcnt(4)
    v_mfma_f32_32x32x16_bf16 v[112:127], v[40:43], v[156:159], v[112:127]
    ds_read_b64_tr_b16 v[56:57], v7 offset:10240
    ds_read_b64_tr_b16 v[58:59], v7 offset:10752
    buffer_load_dwordx4 v13, s[20:23], s83 offen offset:1024 lds
    v_mfma_f32_32x32x16_bf16 v[128:143], v[44:47], v[156:159], v[128:143]
    ds_read_b64_tr_b16 v[60:61], v8 offset:10240
    ds_read_b64_tr_b16 v[62:63], v8 offset:10752
    s_cmp_gt_i32 s94, 2
    s_cselect_b32 s61, 1049335798, 1.0
    s_cselect_b32 s60, 0, s60
    s_cselect_b32 s62, 0, s62
    s_waitcnt lgkmcnt(4)
    v_mfma_f32_32x32x16_bf16 v[112:127], v[48:51], v[160:163], v[112:127]
    ds_read_b64_tr_b16 v[40:41], v7 offset:12288
    ds_read_b64_tr_b16 v[42:43], v7 offset:12800
    buffer_load_dwordx4 v14, s[20:23], s83 offen offset:2048 lds
    v_mov_b32 v28, s60
    v_mfma_f32_32x32x16_bf16 v[128:143], v[52:55], v[160:163], v[128:143]
    ds_read_b64_tr_b16 v[44:45], v8 offset:12288
    ds_read_b64_tr_b16 v[46:47], v8 offset:12800
    buffer_load_dwordx4 v15, s[20:23], s83 offen offset:3072 lds
    v_mov_b32 v29, s62
    s_waitcnt lgkmcnt(4)
    v_mfma_f32_32x32x16_bf16 v[112:127], v[56:59], v[164:167], v[112:127]
    ds_read_b64_tr_b16 v[48:49], v7 offset:14336
    ds_read_b64_tr_b16 v[50:51], v7 offset:14848
    s_add_u32 m0, s82, 53248
    s_add_u32 s83, s83, s77
    buffer_load_dwordx4 v12, s[20:23], s83 offen lds
    v_mfma_f32_32x32x16_bf16 v[128:143], v[60:63], v[164:167], v[128:143]
    ds_read_b64_tr_b16 v[52:53], v8 offset:14336
    ds_read_b64_tr_b16 v[54:55], v8 offset:14848
    v_mul_f32 v96, s61, v96
    v_mul_f32 v97, s61, v97
    v_mul_f32 v98, s61, v98
    s_waitcnt lgkmcnt(4)
    v_mfma_f32_32x32x16_bf16 v[112:127], v[40:43], v[168:171], v[112:127]
    ds_read_b64_tr_b16 v[56:57], v7 offset:16384
    ds_read_b64_tr_b16 v[58:59], v7 offset:16896
    v_mul_f32 v99, s61, v99
    v_mul_f32 v100, s61, v100
    v_mul_f32 v101, s61, v101
    v_mfma_f32_32x32x16_bf16 v[128:143], v[44:47], v[168:171], v[128:143]
    ds_read_b64_tr_b16 v[60:61], v8 offset:16384
    ds_read_b64_tr_b16 v[62:63], v8 offset:16896
    v_mul_f32 v102, s61, v102
    v_mul_f32 v103, s61, v103
    v_mul_f32 v104, s61, v104
    s_waitcnt lgkmcnt(4)
    v_mfma_f32_32x32x16_bf16 v[112:127], v[48:51], v[172:175], v[112:127]
    ds_read_b64_tr_b16 v[40:41], v7 offset:18432
    ds_read_b64_tr_b16 v[42:43], v7 offset:18944
    v_mul_f32 v105, s61, v105
    v_mul_f32 v106, s61, v106
    v_mul_f32 v107, s61, v107
    v_mfma_f32_32x32x16_bf16 v[128:143], v[52:55], v[172:175], v[128:143]
    ds_read_b64_tr_b16 v[44:45], v8 offset:18432
    ds_read_b64_tr_b16 v[46:47], v8 offset:18944
    v_mul_f32 v108, s61, v108
    v_mul_f32 v109, s61, v109
    v_mul_f32 v110, s61, v110
    s_waitcnt lgkmcnt(4)
    v_mfma_f32_32x32x16_bf16 v[112:127], v[56:59], v[176:179], v[112:127]
    ds_read_b64_tr_b16 v[48:49], v7 offset:20480
    ds_read_b64_tr_b16 v[50:51], v7 offset:20992
    buffer_load_dwordx4 v13, s[20:23], s83 offen offset:1024 lds
    v_mul_f32 v111, s61, v111
    v_mfma_f32_32x32x16_bf16 v[128:143], v[60:63], v[176:179], v[128:143]
    ds_read_b64_tr_b16 v[52:53], v8 offset:20480
    ds_read_b64_tr_b16 v[54:55], v8 offset:20992
    buffer_load_dwordx4 v14, s[20:23], s83 offen offset:2048 lds
    v_cvt_pk_bf16_f32 v96, v96, v97
    s_waitcnt lgkmcnt(4)
    v_mfma_f32_32x32x16_bf16 v[112:127], v[40:43], v[180:183], v[112:127]
    ds_read_b64_tr_b16 v[56:57], v7 offset:22528
    ds_read_b64_tr_b16 v[58:59], v7 offset:23040
    buffer_load_dwordx4 v15, s[20:23], s83 offen offset:3072 lds
    v_cvt_pk_bf16_f32 v97, v98, v99
    v_mfma_f32_32x32x16_bf16 v[128:143], v[44:47], v[180:183], v[128:143]
    ds_read_b64_tr_b16 v[60:61], v8 offset:22528
    ds_read_b64_tr_b16 v[62:63], v8 offset:23040
    v_cvt_pk_bf16_f32 v98, v100, v101
    v_cvt_pk_bf16_f32 v99, v102, v103
    v_cvt_pk_bf16_f32 v100, v104, v105
    s_waitcnt lgkmcnt(4)
    v_mfma_f32_32x32x16_bf16 v[112:127], v[48:51], v[184:187], v[112:127]
    s_waitcnt vmcnt(12)
    s_barrier
    ds_read_b64_tr_b16 v[40:41], v7 offset:24576
    ds_read_b64_tr_b16 v[42:43], v7 offset:25088
    s_add_u32 s75, s0, 262144
    buffer_store_dwordx4 v[96:99], v26, s[28:31], s75 offen offset:0 sc1
    v_mfma_f32_32x32x16_bf16 v[128:143], v[52:55], v[184:187], v[128:143]
    ds_read_b64_tr_b16 v[44:45], v8 offset:24576
    ds_read_b64_tr_b16 v[46:47], v8 offset:25088
    s_add_u32 m0, s82, 57344
    s_add_u32 s83, s83, s77
    buffer_load_dwordx4 v12, s[20:23], s83 offen lds
    s_waitcnt lgkmcnt(4)
    v_mfma_f32_32x32x16_bf16 v[112:127], v[56:59], v[188:191], v[112:127]
    ds_read_b64_tr_b16 v[48:49], v7 offset:26624
    ds_read_b64_tr_b16 v[50:51], v7 offset:27136
    v_cvt_pk_bf16_f32 v101, v106, v107
    v_cvt_pk_bf16_f32 v102, v108, v109
    v_cvt_pk_bf16_f32 v103, v110, v111
    v_mfma_f32_32x32x16_bf16 v[128:143], v[60:63], v[188:191], v[128:143]
    ds_read_b64_tr_b16 v[52:53], v8 offset:26624
    ds_read_b64_tr_b16 v[54:55], v8 offset:27136
    v_cndmask_b32 v102, v102, v28, s[64:65]
    v_cndmask_b32 v103, v103, v29, s[64:65]
    s_waitcnt lgkmcnt(4)
    v_mfma_f32_32x32x16_bf16 v[112:127], v[40:43], v[192:195], v[112:127]
    ds_read_b64_tr_b16 v[56:57], v7 offset:28672
    ds_read_b64_tr_b16 v[58:59], v7 offset:29184
    buffer_store_dwordx4 v[100:103], v27, s[28:31], s75 offen offset:1024 sc1
    v_mfma_f32_32x32x16_bf16 v[128:143], v[44:47], v[192:195], v[128:143]
    ds_read_b64_tr_b16 v[60:61], v8 offset:28672
    ds_read_b64_tr_b16 v[62:63], v8 offset:29184
    s_cmp_gt_i32 s94, -15
    s_cselect_b32 s60, 0x3f803f80, s63
    s_cselect_b32 s62, s63, 0
    s_waitcnt lgkmcnt(4)
    v_mfma_f32_32x32x16_bf16 v[112:127], v[48:51], v[196:199], v[112:127]
    ds_read_b64_tr_b16 v[40:41], v7 offset:30720
    ds_read_b64_tr_b16 v[42:43], v7 offset:31232
    buffer_load_dwordx4 v13, s[20:23], s83 offen offset:1024 lds
    v_mfma_f32_32x32x16_bf16 v[128:143], v[52:55], v[196:199], v[128:143]
    ds_read_b64_tr_b16 v[44:45], v8 offset:30720
    ds_read_b64_tr_b16 v[46:47], v8 offset:31232
    s_cmp_gt_i32 s94, 1
    s_cselect_b32 s61, 1049335798, 1.0
    s_cselect_b32 s60, 0, s60
    s_cselect_b32 s62, 0, s62
    s_waitcnt lgkmcnt(4)
    v_mfma_f32_32x32x16_bf16 v[112:127], v[56:59], v[200:203], v[112:127]
    ds_read_b64_tr_b16 v[48:49], v7 offset:32768
    ds_read_b64_tr_b16 v[50:51], v7 offset:33280
    v_mov_b32 v28, s60
    v_mov_b32 v29, s62
    v_mul_f32 v80, s61, v80
    v_mfma_f32_32x32x16_bf16 v[128:143], v[60:63], v[200:203], v[128:143]
    ds_read_b64_tr_b16 v[52:53], v8 offset:32768
    ds_read_b64_tr_b16 v[54:55], v8 offset:33280
    buffer_load_dwordx4 v14, s[20:23], s83 offen offset:2048 lds
    v_mul_f32 v81, s61, v81
    s_waitcnt lgkmcnt(4)
    v_mfma_f32_32x32x16_bf16 v[112:127], v[40:43], v[204:207], v[112:127]
    ds_read_b64_tr_b16 v[56:57], v7 offset:34816
    ds_read_b64_tr_b16 v[58:59], v7 offset:35328
    buffer_load_dwordx4 v15, s[20:23], s83 offen offset:3072 lds
    v_mul_f32 v82, s61, v82
    v_mfma_f32_32x32x16_bf16 v[128:143], v[44:47], v[204:207], v[128:143]
    ds_read_b64_tr_b16 v[60:61], v8 offset:34816
    ds_read_b64_tr_b16 v[62:63], v8 offset:35328
    v_mul_f32 v83, s61, v83
    v_mul_f32 v84, s61, v84
    v_mul_f32 v85, s61, v85
    s_waitcnt lgkmcnt(4)
    v_mfma_f32_32x32x16_bf16 v[112:127], v[48:51], v[208:211], v[112:127]
    ds_read_b64_tr_b16 v[40:41], v7 offset:36864
    ds_read_b64_tr_b16 v[42:43], v7 offset:37376
    v_mul_f32 v86, s61, v86
    v_mul_f32 v87, s61, v87
    v_mul_f32 v88, s61, v88
    v_mfma_f32_32x32x16_bf16 v[128:143], v[52:55], v[208:211], v[128:143]
    ds_read_b64_tr_b16 v[44:45], v8 offset:36864
    ds_read_b64_tr_b16 v[46:47], v8 offset:37376
    v_mul_f32 v89, s61, v89
    v_mul_f32 v90, s61, v90
    v_mul_f32 v91, s61, v91
    s_waitcnt lgkmcnt(4)
    v_mfma_f32_32x32x16_bf16 v[112:127], v[56:59], v[212:215], v[112:127]
    ds_read_b64_tr_b16 v[48:49], v7 offset:38912
    ds_read_b64_tr_b16 v[50:51], v7 offset:39424
    v_mul_f32 v92, s61, v92
    v_mul_f32 v93, s61, v93
    v_mul_f32 v94, s61, v94
    v_mfma_f32_32x32x16_bf16 v[128:143], v[60:63], v[212:215], v[128:143]
    ds_read_b64_tr_b16 v[52:53], v8 offset:38912
    ds_read_b64_tr_b16 v[54:55], v8 offset:39424
    v_mul_f32 v95, s61, v95
    v_cvt_pk_bf16_f32 v104, v80, v81
    v_cvt_pk_bf16_f32 v105, v82, v83
    s_waitcnt lgkmcnt(4)
    v_mfma_f32_32x32x16_bf16 v[112:127], v[40:43], v[216:219], v[112:127]
    ds_read_b64_tr_b16 v[56:57], v7 offset:40960
    ds_read_b64_tr_b16 v[58:59], v7 offset:41472
    v_cvt_pk_bf16_f32 v106, v84, v85
    v_cvt_pk_bf16_f32 v107, v86, v87
    v_cvt_pk_bf16_f32 v108, v88, v89
    v_mfma_f32_32x32x16_bf16 v[128:143], v[44:47], v[216:219], v[128:143]
    ds_read_b64_tr_b16 v[60:61], v8 offset:40960
    ds_read_b64_tr_b16 v[62:63], v8 offset:41472
    s_add_u32 s75, s0, 131072
    buffer_store_dwordx4 v[104:107], v24, s[28:31], s75 offen offset:0 sc1
    s_waitcnt lgkmcnt(4)
    v_mfma_f32_32x32x16_bf16 v[112:127], v[48:51], v[220:223], v[112:127]
    ds_read_b64_tr_b16 v[40:41], v7 offset:43008
    ds_read_b64_tr_b16 v[42:43], v7 offset:43520
    v_cvt_pk_bf16_f32 v109, v90, v91
    v_cvt_pk_bf16_f32 v110, v92, v93
    v_cvt_pk_bf16_f32 v111, v94, v95
    v_mfma_f32_32x32x16_bf16 v[128:143], v[52:55], v[220:223], v[128:143]
    ds_read_b64_tr_b16 v[44:45], v8 offset:43008
    ds_read_b64_tr_b16 v[46:47], v8 offset:43520
    v_cndmask_b32 v110, v110, v28, s[64:65]
    v_cndmask_b32 v111, v111, v29, s[64:65]
    s_waitcnt lgkmcnt(4)
    v_mfma_f32_32x32x16_bf16 v[112:127], v[56:59], v[224:227], v[112:127]
    ds_read_b64_tr_b16 v[48:49], v7 offset:45056
    ds_read_b64_tr_b16 v[50:51], v7 offset:45568
    buffer_store_dwordx4 v[108:111], v25, s[28:31], s75 offen offset:1024 sc1
    v_mfma_f32_32x32x16_bf16 v[128:143], v[60:63], v[224:227], v[128:143]
    ds_read_b64_tr_b16 v[52:53], v8 offset:45056
    ds_read_b64_tr_b16 v[54:55], v8 offset:45568
    s_cmp_gt_i32 s94, -16
    s_cselect_b32 s60, 0x3f803f80, s63
    s_cselect_b32 s62, s63, 0
    s_waitcnt lgkmcnt(4)
    v_mfma_f32_32x32x16_bf16 v[112:127], v[40:43], v[228:231], v[112:127]
    ds_read_b64_tr_b16 v[56:57], v7 offset:47104
    ds_read_b64_tr_b16 v[58:59], v7 offset:47616
    s_cmp_gt_i32 s94, 0
    s_cselect_b32 s61, 1049335798, 1.0
    s_cselect_b32 s60, 0, s60
    s_cselect_b32 s62, 0, s62
    v_mfma_f32_32x32x16_bf16 v[128:143], v[44:47], v[228:231], v[128:143]
    ds_read_b64_tr_b16 v[60:61], v8 offset:47104
    ds_read_b64_tr_b16 v[62:63], v8 offset:47616
    v_mov_b32 v28, s60
    v_mov_b32 v29, s62
    v_mul_f32 v64, s61, v64
    s_waitcnt lgkmcnt(4)
    v_mfma_f32_32x32x16_bf16 v[112:127], v[48:51], v[232:235], v[112:127]
    ds_read_b64_tr_b16 v[40:41], v7 offset:49152
    ds_read_b64_tr_b16 v[42:43], v7 offset:49664
    v_mul_f32 v65, s61, v65
    v_mul_f32 v66, s61, v66
    v_mul_f32 v67, s61, v67
    v_mfma_f32_32x32x16_bf16 v[128:143], v[52:55], v[232:235], v[128:143]
    ds_read_b64_tr_b16 v[44:45], v8 offset:49152
    ds_read_b64_tr_b16 v[46:47], v8 offset:49664
    v_mul_f32 v68, s61, v68
    v_mul_f32 v69, s61, v69
    v_mul_f32 v70, s61, v70
    s_waitcnt lgkmcnt(4)
    v_mfma_f32_32x32x16_bf16 v[112:127], v[56:59], v[236:239], v[112:127]
    ds_read_b64_tr_b16 v[48:49], v7 offset:51200
    ds_read_b64_tr_b16 v[50:51], v7 offset:51712
    v_mul_f32 v71, s61, v71
    v_mul_f32 v72, s61, v72
    v_mul_f32 v73, s61, v73
    v_mfma_f32_32x32x16_bf16 v[128:143], v[60:63], v[236:239], v[128:143]
    ds_read_b64_tr_b16 v[52:53], v8 offset:51200
    ds_read_b64_tr_b16 v[54:55], v8 offset:51712
    v_mul_f32 v74, s61, v74
    v_mul_f32 v75, s61, v75
    v_mul_f32 v76, s61, v76
    s_waitcnt lgkmcnt(4)
    v_mfma_f32_32x32x16_bf16 v[112:127], v[40:43], v[240:243], v[112:127]
    ds_read_b64_tr_b16 v[56:57], v7 offset:53248
    ds_read_b64_tr_b16 v[58:59], v7 offset:53760
    v_mul_f32 v77, s61, v77
    v_mul_f32 v78, s61, v78
    v_mul_f32 v79, s61, v79
    v_mfma_f32_32x32x16_bf16 v[128:143], v[44:47], v[240:243], v[128:143]
    ds_read_b64_tr_b16 v[60:61], v8 offset:53248
    ds_read_b64_tr_b16 v[62:63], v8 offset:53760
    v_cvt_pk_bf16_f32 v32, v64, v65
    v_cvt_pk_bf16_f32 v33, v66, v67
    v_cvt_pk_bf16_f32 v34, v68, v69
    s_waitcnt lgkmcnt(4)
    v_mfma_f32_32x32x16_bf16 v[112:127], v[48:51], v[244:247], v[112:127]
    ds_read_b64_tr_b16 v[40:41], v7 offset:55296
    ds_read_b64_tr_b16 v[42:43], v7 offset:55808
    v_cvt_pk_bf16_f32 v35, v70, v71
    v_cvt_pk_bf16_f32 v36, v72, v73
    v_cvt_pk_bf16_f32 v37, v74, v75
    v_mfma_f32_32x32x16_bf16 v[128:143], v[52:55], v[244:247], v[128:143]
    ds_read_b64_tr_b16 v[44:45], v8 offset:55296
    ds_read_b64_tr_b16 v[46:47], v8 offset:55808
    s_add_u32 s75, s0, 0
    buffer_store_dwordx4 v[32:35], v24, s[28:31], s75 offen offset:0 sc1
    s_waitcnt lgkmcnt(4)
    v_mfma_f32_32x32x16_bf16 v[112:127], v[56:59], v[248:251], v[112:127]
    v_cvt_pk_bf16_f32 v38, v76, v77
    v_cvt_pk_bf16_f32 v39, v78, v79
    v_cndmask_b32 v38, v38, v28, s[64:65]
    v_cndmask_b32 v39, v39, v29, s[64:65]
    buffer_store_dwordx4 v[36:39], v25, s[28:31], s75 offen offset:1024 sc1
    ds_read2_b64 v[72:75], v23 offset0:208 offset1:210
    ds_read2_b64 v[76:79], v23 offset0:212 offset1:214
    ds_read2_b64 v[88:91], v23 offset0:216 offset1:218
    ds_read2_b64 v[92:95], v23 offset0:220 offset1:222
    s_waitcnt lgkmcnt(3)
    v_lshlrev_b32 v64, 16, v72
    s_add_u32 m0, s81, 16384
    s_mul_i32 s76, s70, 229376
    s_add_u32 s76, s76, s52
    buffer_load_dwordx4 v9, s[16:19], s76 offen lds
    v_and_b32 v65, 0xffff0000, v72
    v_lshlrev_b32 v66, 16, v73
    v_and_b32 v67, 0xffff0000, v73
    v_lshlrev_b32 v68, 16, v74
    v_and_b32 v69, 0xffff0000, v74
    v_lshlrev_b32 v70, 16, v75
    v_and_b32 v71, 0xffff0000, v75
    s_waitcnt lgkmcnt(2)
    v_lshlrev_b32 v72, 16, v76
    v_and_b32 v73, 0xffff0000, v76
    v_lshlrev_b32 v74, 16, v77
    v_and_b32 v75, 0xffff0000, v77
    v_lshlrev_b32 v76, 16, v78
    v_and_b32 v77, 0xffff0000, v78
    v_lshlrev_b32 v78, 16, v79
    v_and_b32 v79, 0xffff0000, v79
    s_waitcnt lgkmcnt(1)
    v_lshlrev_b32 v80, 16, v88
    buffer_load_dwordx4 v10, s[16:19], s76 offen offset:1024 lds
    v_and_b32 v81, 0xffff0000, v88
    v_lshlrev_b32 v82, 16, v89
    v_and_b32 v83, 0xffff0000, v89
    v_lshlrev_b32 v84, 16, v90
    v_and_b32 v85, 0xffff0000, v90
    v_lshlrev_b32 v86, 16, v91
    v_and_b32 v87, 0xffff0000, v91
    s_waitcnt lgkmcnt(0)
    v_lshlrev_b32 v88, 16, v92
    s_add_u32 m0, s81, 24576
    s_mul_i32 s76, s71, 229376
    s_add_u32 s76, s76, s52
    buffer_load_dwordx4 v9, s[16:19], s76 offen lds
    v_and_b32 v89, 0xffff0000, v92
    v_lshlrev_b32 v90, 16, v93
    v_and_b32 v91, 0xffff0000, v93
    v_lshlrev_b32 v92, 16, v94
    v_and_b32 v93, 0xffff0000, v94
    buffer_load_dwordx4 v10, s[16:19], s76 offen offset:1024 lds
    v_lshlrev_b32 v94, 16, v95
    v_and_b32 v95, 0xffff0000, v95
    s_waitcnt vmcnt(22)
    s_barrier
L_heavy:
    v_add_u32 v7, 106496, v7
    v_add_u32 v8, 106496, v8
    ds_read_b64_tr_b16 v[48:49], v7 offset:0
    ds_read_b64_tr_b16 v[50:51], v7 offset:512
    s_add_u32 m0, s81, 32768
    s_mul_i32 s76, s72, 229376
    s_add_u32 s76, s76, s52
    buffer_load_dwordx4 v9, s[16:19], s76 offen lds
    v_mfma_f32_32x32x16_bf16 v[128:143], v[60:63], v[248:251], v[128:143]
    ds_read_b64_tr_b16 v[52:53], v8 offset:0
    ds_read_b64_tr_b16 v[54:55], v8 offset:512
    buffer_load_dwordx4 v10, s[16:19], s76 offen offset:1024 lds
    v_mfma_f32_32x32x16_bf16 v[112:127], v[40:43], v[252:255], v[112:127]
    ds_read_b64_tr_b16 v[56:57], v7 offset:2048
    ds_read_b64_tr_b16 v[58:59], v7 offset:2560
    s_add_u32 m0, s81, 40960
    s_mul_i32 s76, s73, 229376
    s_add_u32 s76, s76, s52
    buffer_load_dwordx4 v9, s[16:19], s76 offen lds
    v_mfma_f32_32x32x16_bf16 v[128:143], v[44:47], v[252:255], v[128:143]
    ds_read_b64_tr_b16 v[60:61], v8 offset:2048
    ds_read_b64_tr_b16 v[62:63], v8 offset:2560
    s_waitcnt vmcnt(21)
    ds_read_b64_tr_b16 a[0:1], v16 offset:49152
    ds_read_b64_tr_b16 a[2:3], v16 offset:50176
    s_waitcnt lgkmcnt(6)
    v_mfma_f32_32x32x16_bf16 v[64:79], v[48:51], v[144:147], v[64:79]
    ds_read_b64_tr_b16 v[40:41], v7 offset:4096
    ds_read_b64_tr_b16 v[42:43], v7 offset:4608
    ds_read_b64_tr_b16 a[4:5], v17 offset:49152
    ds_read_b64_tr_b16 a[6:7], v17 offset:50176
    v_mul_f32 v22, 3216550459, v112
    v_mfma_f32_32x32x16_bf16 v[80:95], v[52:55], v[144:147], v[80:95]
    ds_read_b64_tr_b16 v[44:45], v8 offset:4096
    ds_read_b64_tr_b16 v[46:47], v8 offset:4608
    ds_read_b64_tr_b16 a[8:9], v16 offset:51200
    ds_read_b64_tr_b16 a[10:11], v16 offset:52224
    s_waitcnt lgkmcnt(10)
    v_mfma_f32_32x32x16_bf16 v[64:79], v[56:59], v[148:151], v[64:79]
    ds_read_b64_tr_b16 v[48:49], v7 offset:6144
    ds_read_b64_tr_b16 v[50:51], v7 offset:6656
    ds_read_b64_tr_b16 a[12:13], v17 offset:51200
    ds_read_b64_tr_b16 a[14:15], v17 offset:52224
    v_mfma_f32_32x32x16_bf16 v[80:95], v[60:63], v[148:151], v[80:95]
    ds_read_b64_tr_b16 v[52:53], v8 offset:6144
    ds_read_b64_tr_b16 v[54:55], v8 offset:6656
    buffer_load_dwordx4 v10, s[16:19], s76 offen offset:1024 lds
    s_waitcnt lgkmcnt(8)
    v_mfma_f32_32x32x16_bf16 v[64:79], v[40:43], v[152:155], v[64:79]
    ds_read_b64_tr_b16 v[56:57], v7 offset:8192
    ds_read_b64_tr_b16 v[58:59], v7 offset:8704
    s_waitcnt vmcnt(18)
    ds_read_b64_tr_b16 a[16:17], v16 offset:53248
    ds_read_b64_tr_b16 a[18:19], v16 offset:54272
    v_mfma_f32_32x32x16_bf16 v[80:95], v[44:47], v[152:155], v[80:95]
    ds_read_b64_tr_b16 v[60:61], v8 offset:8192
    ds_read_b64_tr_b16 v[62:63], v8 offset:8704
    ds_read_b64_tr_b16 a[20:21], v17 offset:53248
    ds_read_b64_tr_b16 a[22:23], v17 offset:54272
    s_waitcnt lgkmcnt(8)
    v_mfma_f32_32x32x16_bf16 v[64:79], v[48:51], v[156:159], v[64:79]
    ds_read_b64_tr_b16 v[40:41], v7 offset:10240
    ds_read_b64_tr_b16 v[42:43], v7 offset:10752
    s_waitcnt vmcnt(8)
    buffer_store_dword v2, v3, s[28:31], s5 offen sc1
    v_mfma_f32_32x32x16_bf16 v[80:95], v[52:55], v[156:159], v[80:95]
    ds_read_b64_tr_b16 v[44:45], v8 offset:10240
    ds_read_b64_tr_b16 v[46:47], v8 offset:10752
    s_add_u32 m0, s81, 49152
    s_mul_i32 s76, s74, 229376
    s_add_u32 s76, s76, s52
    buffer_load_dwordx4 v9, s[16:19], s76 offen lds
    s_waitcnt lgkmcnt(6)
    v_mfma_f32_32x32x16_bf16 v[64:79], v[56:59], v[160:163], v[64:79]
    ds_read_b64_tr_b16 v[48:49], v7 offset:12288
    ds_read_b64_tr_b16 v[50:51], v7 offset:12800
    buffer_load_dwordx4 v10, s[16:19], s76 offen offset:1024 lds
    v_mfma_f32_32x32x16_bf16 v[80:95], v[60:63], v[160:163], v[80:95]
    ds_read_b64_tr_b16 v[52:53], v8 offset:12288
    ds_read_b64_tr_b16 v[54:55], v8 offset:12800
    ds_read_b64_tr_b16 a[24:25], v16 offset:55296
    ds_read_b64_tr_b16 a[26:27], v16 offset:56320
    s_waitcnt lgkmcnt(6)
    v_mfma_f32_32x32x16_bf16 v[64:79], v[40:43], v[164:167], v[64:79]
    ds_read_b64_tr_b16 v[56:57], v7 offset:14336
    ds_read_b64_tr_b16 v[58:59], v7 offset:14848
    s_mov_b32 m0, s82
    s_add_u32 s83, s83, s77
    buffer_load_dwordx4 v12, s[20:23], s83 offen lds
    v_mfma_f32_32x32x16_bf16 v[80:95], v[44:47], v[164:167], v[80:95]
    ds_read_b64_tr_b16 v[60:61], v8 offset:14336
    ds_read_b64_tr_b16 v[62:63], v8 offset:14848
    buffer_load_dwordx4 v13, s[20:23], s83 offen offset:1024 lds
    s_waitcnt lgkmcnt(6)
    v_mfma_f32_32x32x16_bf16 v[64:79], v[48:51], v[168:171], v[64:79]
    s_waitcnt vmcnt(9)
    s_barrier
    ds_read_b64_tr_b16 v[40:41], v7 offset:16384
    ds_read_b64_tr_b16 v[42:43], v7 offset:16896
    buffer_load_dwordx4 v14, s[20:23], s83 offen offset:2048 lds
    v_mfma_f32_32x32x16_bf16 v[80:95], v[52:55], v[168:171], v[80:95]
    ds_read_b64_tr_b16 v[44:45], v8 offset:16384
    ds_read_b64_tr_b16 v[46:47], v8 offset:16896
    buffer_load_dwordx4 v15, s[20:23], s83 offen offset:3072 lds
    s_waitcnt lgkmcnt(4)
    v_mfma_f32_32x32x16_bf16 v[64:79], v[56:59], v[172:175], v[64:79]
    ds_read_b64_tr_b16 v[48:49], v7 offset:18432
    ds_read_b64_tr_b16 v[50:51], v7 offset:18944
    s_add_u32 m0, s82, 4096
    s_add_u32 s83, s83, s77
    buffer_load_dwordx4 v12, s[20:23], s83 offen lds
    v_mfma_f32_32x32x16_bf16 v[80:95], v[60:63], v[172:175], v[80:95]
    ds_read_b64_tr_b16 v[52:53], v8 offset:18432
    ds_read_b64_tr_b16 v[54:55], v8 offset:18944
    ds_read_b64_tr_b16 a[28:29], v17 offset:55296
    ds_read_b64_tr_b16 a[30:31], v17 offset:56320
    s_waitcnt lgkmcnt(6)
    v_mfma_f32_32x32x16_bf16 v[64:79], v[40:43], v[176:179], v[64:79]
    ds_read_b64_tr_b16 v[56:57], v7 offset:20480
    ds_read_b64_tr_b16 v[58:59], v7 offset:20992
    buffer_load_dwordx4 v13, s[20:23], s83 offen offset:1024 lds
    v_mfma_f32_32x32x16_bf16 v[80:95], v[44:47], v[176:179], v[80:95]
    ds_read_b64_tr_b16 v[60:61], v8 offset:20480
    ds_read_b64_tr_b16 v[62:63], v8 offset:20992
    buffer_load_dwordx4 v14, s[20:23], s83 offen offset:2048 lds
    s_waitcnt lgkmcnt(6)
    v_mfma_f32_32x32x16_bf16 v[64:79], v[48:51], v[180:183], v[64:79]
    ds_read_b64_tr_b16 v[40:41], v7 offset:22528
    ds_read_b64_tr_b16 v[42:43], v7 offset:23040
    ds_read_b64_tr_b16 a[32:33], v16 offset:57344
    ds_read_b64_tr_b16 a[34:35], v16 offset:58368
    v_mfma_f32_32x32x16_bf16 v[80:95], v[52:55], v[180:183], v[80:95]
    ds_read_b64_tr_b16 v[44:45], v8 offset:22528
    ds_read_b64_tr_b16 v[46:47], v8 offset:23040
    ds_read_b64_tr_b16 a[36:37], v17 offset:57344
    ds_read_b64_tr_b16 a[38:39], v17 offset:58368
    s_waitcnt lgkmcnt(8)
    v_mfma_f32_32x32x16_bf16 v[64:79], v[56:59], v[184:187], v[64:79]
    ds_read_b64_tr_b16 v[48:49], v7 offset:24576
    ds_read_b64_tr_b16 v[50:51], v7 offset:25088
    ds_read_b64_tr_b16 a[40:41], v16 offset:59392
    ds_read_b64_tr_b16 a[42:43], v16 offset:60416
    v_mfma_f32_32x32x16_bf16 v[80:95], v[60:63], v[184:187], v[80:95]
    ds_read_b64_tr_b16 v[52:53], v8 offset:24576
    ds_read_b64_tr_b16 v[54:55], v8 offset:25088
    ds_read_b64_tr_b16 a[44:45], v17 offset:59392
    ds_read_b64_tr_b16 a[46:47], v17 offset:60416
    s_waitcnt lgkmcnt(10)
    v_mfma_f32_32x32x16_bf16 v[64:79], v[40:43], v[188:191], v[64:79]
    ds_read_b64_tr_b16 v[56:57], v7 offset:26624
    ds_read_b64_tr_b16 v[58:59], v7 offset:27136
    v_exp_f32 v22, v22
    v_and_b32 v21, 31, v0
    v_mfma_f32_32x32x16_bf16 v[80:95], v[44:47], v[188:191], v[80:95]
    ds_read_b64_tr_b16 v[60:61], v8 offset:26624
    ds_read_b64_tr_b16 v[62:63], v8 offset:27136
    v_add_f32 v22, 1.0, v22
    v_lshlrev_b32 v21, 2, v21
    s_waitcnt lgkmcnt(6)
    v_mfma_f32_32x32x16_bf16 v[64:79], v[48:51], v[192:195], v[64:79]
    ds_read_b64_tr_b16 v[40:41], v7 offset:28672
    ds_read_b64_tr_b16 v[42:43], v7 offset:29184
    v_rcp_f32 v22, v22
    v_mov_b32 v24, 1073741824
    v_mfma_f32_32x32x16_bf16 v[80:95], v[52:55], v[192:195], v[80:95]
    ds_read_b64_tr_b16 v[44:45], v8 offset:28672
    ds_read_b64_tr_b16 v[46:47], v8 offset:29184
    v_cndmask_b32 v24, v21, v24, s[64:65]
    v_mul_f32 v36, v112, v112
    v_fma_f32 v36, v36, s26, v4
    s_waitcnt lgkmcnt(4)
    v_mfma_f32_32x32x16_bf16 v[64:79], v[56:59], v[196:199], v[64:79]
    ds_read_b64_tr_b16 v[48:49], v7 offset:30720
    ds_read_b64_tr_b16 v[50:51], v7 offset:31232
    buffer_store_dword v22, v24, s[28:31], s6 offen sc1
    v_mul_f32 v36, v36, v112
    v_mfma_f32_32x32x16_bf16 v[80:95], v[60:63], v[196:199], v[80:95]
    ds_read_b64_tr_b16 v[52:53], v8 offset:30720
    ds_read_b64_tr_b16 v[54:55], v8 offset:31232
    v_mul_f32 v37, v113, v113
    v_fma_f32 v37, v37, s26, v4
    v_mul_f32 v37, v37, v113
    s_waitcnt lgkmcnt(4)
    v_mfma_f32_32x32x16_bf16 v[64:79], v[40:43], v[200:203], v[64:79]
    s_waitcnt vmcnt(8)
    s_barrier
    ds_read_b64_tr_b16 v[56:57], v7 offset:32768
    ds_read_b64_tr_b16 v[58:59], v7 offset:33280
    buffer_load_dwordx4 v15, s[20:23], s83 offen offset:3072 lds
    v_mul_f32 v38, v114, v114
    v_mfma_f32_32x32x16_bf16 v[80:95], v[44:47], v[200:203], v[80:95]
    ds_read_b64_tr_b16 v[60:61], v8 offset:32768
    ds_read_b64_tr_b16 v[62:63], v8 offset:33280
    s_add_u32 m0, s82, 8192
    s_add_u32 s83, s83, s77
    buffer_load_dwordx4 v12, s[20:23], s83 offen lds
    s_waitcnt lgkmcnt(4)
    v_mfma_f32_32x32x16_bf16 v[64:79], v[48:51], v[204:207], v[64:79]
    ds_read_b64_tr_b16 v[40:41], v7 offset:34816
    ds_read_b64_tr_b16 v[42:43], v7 offset:35328
    buffer_load_dwordx4 v13, s[20:23], s83 offen offset:1024 lds
    v_fma_f32 v38, v38, s26, v4
    v_mfma_f32_32x32x16_bf16 v[80:95], v[52:55], v[204:207], v[80:95]
    ds_read_b64_tr_b16 v[44:45], v8 offset:34816
    ds_read_b64_tr_b16 v[46:47], v8 offset:35328
    buffer_load_dwordx4 v14, s[20:23], s83 offen offset:2048 lds
    v_mul_f32 v38, v38, v114
    s_waitcnt lgkmcnt(4)
    v_mfma_f32_32x32x16_bf16 v[64:79], v[56:59], v[208:211], v[64:79]
    ds_read_b64_tr_b16 v[48:49], v7 offset:36864
    ds_read_b64_tr_b16 v[50:51], v7 offset:37376
    s_waitcnt vmcnt(8)
    ds_read_b64_tr_b16 a[48:49], v16 offset:0
    ds_read_b64_tr_b16 a[50:51], v16 offset:1024
    v_mfma_f32_32x32x16_bf16 v[80:95], v[60:63], v[208:211], v[80:95]
    ds_read_b64_tr_b16 v[52:53], v8 offset:36864
    ds_read_b64_tr_b16 v[54:55], v8 offset:37376
    buffer_load_dwordx4 v15, s[20:23], s83 offen offset:3072 lds
    v_mul_f32 v39, v115, v115
    s_waitcnt lgkmcnt(6)
    v_mfma_f32_32x32x16_bf16 v[64:79], v[40:43], v[212:215], v[64:79]
    ds_read_b64_tr_b16 v[56:57], v7 offset:38912
    ds_read_b64_tr_b16 v[58:59], v7 offset:39424
    s_add_u32 m0, s82, 49152
    s_add_u32 s83, s83, s77
    buffer_load_dwordx4 v12, s[20:23], s83 offen lds
    v_mfma_f32_32x32x16_bf16 v[80:95], v[44:47], v[212:215], v[80:95]
    ds_read_b64_tr_b16 v[60:61], v8 offset:38912
    ds_read_b64_tr_b16 v[62:63], v8 offset:39424
    buffer_load_dwordx4 v13, s[20:23], s83 offen offset:1024 lds
    v_fma_f32 v39, v39, s26, v4
    s_waitcnt lgkmcnt(4)
    v_mfma_f32_32x32x16_bf16 v[64:79], v[48:51], v[216:219], v[64:79]
    ds_read_b64_tr_b16 v[40:41], v7 offset:40960
    ds_read_b64_tr_b16 v[42:43], v7 offset:41472
    ds_read_b64_tr_b16 a[52:53], v17 offset:0
    ds_read_b64_tr_b16 a[54:55], v17 offset:1024
    v_mul_f32 v39, v39, v115
    v_mfma_f32_32x32x16_bf16 v[80:95], v[52:55], v[216:219], v[80:95]
    ds_read_b64_tr_b16 v[44:45], v8 offset:40960
    ds_read_b64_tr_b16 v[46:47], v8 offset:41472
    buffer_load_dwordx4 v14, s[20:23], s83 offen offset:2048 lds
    s_waitcnt lgkmcnt(6)
    v_mfma_f32_32x32x16_bf16 v[64:79], v[56:59], v[220:223], v[64:79]
    ds_read_b64_tr_b16 v[48:49], v7 offset:43008
    ds_read_b64_tr_b16 v[50:51], v7 offset:43520
    buffer_load_dwordx4 v15, s[20:23], s83 offen offset:3072 lds
    v_mfma_f32_32x32x16_bf16 v[80:95], v[60:63], v[220:223], v[80:95]
    ds_read_b64_tr_b16 v[52:53], v8 offset:43008
    ds_read_b64_tr_b16 v[54:55], v8 offset:43520
    ds_read_b64_tr_b16 a[56:57], v16 offset:2048
    ds_read_b64_tr_b16 a[58:59], v16 offset:3072
    s_waitcnt lgkmcnt(6)
    v_mfma_f32_32x32x16_bf16 v[64:79], v[40:43], v[224:227], v[64:79]
    ds_read_b64_tr_b16 v[56:57], v7 offset:45056
    ds_read_b64_tr_b16 v[58:59], v7 offset:45568
    ds_read_b64_tr_b16 a[60:61], v17 offset:2048
    ds_read_b64_tr_b16 a[62:63], v17 offset:3072
    v_mfma_f32_32x32x16_bf16 v[80:95], v[44:47], v[224:227], v[80:95]
    ds_read_b64_tr_b16 v[60:61], v8 offset:45056
    ds_read_b64_tr_b16 v[62:63], v8 offset:45568
    v_exp_f32 v36, v36
    s_waitcnt lgkmcnt(8)
    v_mfma_f32_32x32x16_bf16 v[64:79], v[48:51], v[228:231], v[64:79]
    ds_read_b64_tr_b16 v[40:41], v7 offset:47104
    ds_read_b64_tr_b16 v[42:43], v7 offset:47616
    v_exp_f32 v37, v37
    v_mfma_f32_32x32x16_bf16 v[80:95], v[52:55], v[228:231], v[80:95]
    ds_read_b64_tr_b16 v[44:45], v8 offset:47104
    ds_read_b64_tr_b16 v[46:47], v8 offset:47616
    v_exp_f32 v38, v38
    s_waitcnt lgkmcnt(4)
    v_mfma_f32_32x32x16_bf16 v[64:79], v[56:59], v[232:235], v[64:79]
    ds_read_b64_tr_b16 v[48:49], v7 offset:49152
    ds_read_b64_tr_b16 v[50:51], v7 offset:49664
    v_exp_f32 v39, v39
    v_add_f32 v36, 1.0, v36
    v_mfma_f32_32x32x16_bf16 v[80:95], v[60:63], v[232:235], v[80:95]
    ds_read_b64_tr_b16 v[52:53], v8 offset:49152
    ds_read_b64_tr_b16 v[54:55], v8 offset:49664
    v_add_f32 v37, 1.0, v37
    v_add_f32 v38, 1.0, v38
    v_add_f32 v39, 1.0, v39
    s_waitcnt lgkmcnt(4)
    v_mfma_f32_32x32x16_bf16 v[64:79], v[40:43], v[236:239], v[64:79]
    ds_read_b64_tr_b16 v[56:57], v7 offset:51200
    ds_read_b64_tr_b16 v[58:59], v7 offset:51712
    v_rcp_f32 v36, v36
    v_mfma_f32_32x32x16_bf16 v[80:95], v[44:47], v[236:239], v[80:95]
    ds_read_b64_tr_b16 v[60:61], v8 offset:51200
    ds_read_b64_tr_b16 v[62:63], v8 offset:51712
    buffer_load_dword v20, v18, s[28:31], 0 offen sc1
    s_waitcnt lgkmcnt(4)
    v_mfma_f32_32x32x16_bf16 v[64:79], v[48:51], v[240:243], v[64:79]
    ds_read_b64_tr_b16 v[40:41], v7 offset:53248
    ds_read_b64_tr_b16 v[42:43], v7 offset:53760
    s_add_u32 m0, s82, 53248
    s_add_u32 s83, s83, s77
    buffer_load_dwordx4 v12, s[20:23], s83 offen lds
    v_mfma_f32_32x32x16_bf16 v[80:95], v[52:55], v[240:243], v[80:95]
    ds_read_b64_tr_b16 v[44:45], v8 offset:53248
    ds_read_b64_tr_b16 v[46:47], v8 offset:53760
    buffer_load_dwordx4 v13, s[20:23], s83 offen offset:1024 lds
    s_waitcnt lgkmcnt(4)
    v_mfma_f32_32x32x16_bf16 v[64:79], v[56:59], v[244:247], v[64:79]
    ds_read_b64_tr_b16 v[48:49], v7 offset:55296
    ds_read_b64_tr_b16 v[50:51], v7 offset:55808
    buffer_load_dwordx4 v14, s[20:23], s83 offen offset:2048 lds
    v_mfma_f32_32x32x16_bf16 v[80:95], v[60:63], v[244:247], v[80:95]
    ds_read_b64_tr_b16 v[52:53], v8 offset:55296
    ds_read_b64_tr_b16 v[54:55], v8 offset:55808
    buffer_load_dwordx4 v15, s[20:23], s83 offen offset:3072 lds
    s_waitcnt lgkmcnt(4)
    v_mfma_f32_32x32x16_bf16 v[64:79], v[40:43], v[248:251], v[64:79]
    s_waitcnt vmcnt(13)
    ds_read_b64_tr_b16 a[64:65], v16 offset:4096
    ds_read_b64_tr_b16 a[66:67], v16 offset:5120
    v_mfma_f32_32x32x16_bf16 v[80:95], v[44:47], v[248:251], v[80:95]
    s_add_u32 m0, s82, 57344
    s_add_u32 s83, s83, s77
    buffer_load_dwordx4 v12, s[20:23], s83 offen lds
    s_waitcnt lgkmcnt(2)
    v_mfma_f32_32x32x16_bf16 v[64:79], v[48:51], v[252:255], v[64:79]
    buffer_load_dwordx4 v13, s[20:23], s83 offen offset:1024 lds
    v_mfma_f32_32x32x16_bf16 v[80:95], v[52:55], v[252:255], v[80:95]
    ds_read_b64_tr_b16 a[68:69], v17 offset:4096
    ds_read_b64_tr_b16 a[70:71], v17 offset:5120
    s_barrier
    v_lshlrev_b32 v25, 2, v0
    buffer_load_dwordx4 v14, s[20:23], s83 offen offset:2048 lds
    v_rcp_f32 v37, v37
    s_mov_b32 m0, 0
    s_lshl_b32 s76, s55, 7
    buffer_load_dword v25, s[40:43], s76 offen lds
    ds_read_b64_tr_b16 a[72:73], v16 offset:6144
    ds_read_b64_tr_b16 a[74:75], v16 offset:7168
    ds_read_b64_tr_b16 a[76:77], v17 offset:6144
    ds_read_b64_tr_b16 a[78:79], v17 offset:7168
    v_rcp_f32 v38, v38
    s_waitcnt vmcnt(13)
    ds_read_b64_tr_b16 a[80:81], v16 offset:8192
    ds_read_b64_tr_b16 a[82:83], v16 offset:9216
    ds_read_b64_tr_b16 a[84:85], v17 offset:8192
    ds_read_b64_tr_b16 a[86:87], v17 offset:9216
    v_rcp_f32 v39, v39
    s_add_u32 m0, s82, 57344
    s_nop 0
    buffer_load_dwordx4 v15, s[20:23], s83 offen offset:3072 lds
    ds_read_b64_tr_b16 a[88:89], v16 offset:10240
    ds_read_b64_tr_b16 a[90:91], v16 offset:11264
    ds_read_b64_tr_b16 a[92:93], v17 offset:10240
    ds_read_b64_tr_b16 a[94:95], v17 offset:11264
    v_mul_f32 v36, v36, v112
    s_mov_b32 m0, s82
    s_add_u32 s83, s83, s77
    buffer_load_dwordx4 v12, s[20:23], s83 offen lds
    s_waitcnt vmcnt(11)
    ds_read_b64_tr_b16 a[96:97], v16 offset:49152
    ds_read_b64_tr_b16 a[98:99], v16 offset:50176
    ds_read_b64_tr_b16 a[100:101], v17 offset:49152
    ds_read_b64_tr_b16 a[102:103], v17 offset:50176
    v_mul_f32 v37, v37, v113
    ds_read_b64_tr_b16 a[104:105], v16 offset:51200
    ds_read_b64_tr_b16 a[106:107], v16 offset:52224
    ds_read_b64_tr_b16 a[108:109], v17 offset:51200
    ds_read_b64_tr_b16 a[110:111], v17 offset:52224
    v_mul_f32 v38, v38, v114
    v_mul_f32 v39, v39, v115
    v_cvt_pk_bf16_f32 v112, v36, v37
    v_cvt_pk_bf16_f32 v113, v38, v39
    v_pk_mul_f32 v[36:37], v[116:117], v[116:117]
    v_pk_fma_f32 v[36:37], v[36:37], s[26:27], v[4:5] op_sel_hi:[1,1,0]
    v_pk_mul_f32 v[36:37], v[36:37], v[116:117]
    v_pk_mul_f32 v[38:39], v[118:119], v[118:119]
    v_pk_fma_f32 v[38:39], v[38:39], s[26:27], v[4:5] op_sel_hi:[1,1,0]
    v_pk_mul_f32 v[38:39], v[38:39], v[118:119]
    v_exp_f32 v36, v36
    v_exp_f32 v37, v37
    v_exp_f32 v38, v38
    v_exp_f32 v39, v39
    buffer_load_dwordx4 v13, s[20:23], s83 offen offset:1024 lds
    v_pk_add_f32 v[36:37], v[36:37], 1.0 op_sel_hi:[1,0]
    v_pk_add_f32 v[38:39], v[38:39], 1.0 op_sel_hi:[1,0]
    v_rcp_f32 v36, v36
    v_rcp_f32 v37, v37
    v_rcp_f32 v38, v38
    v_rcp_f32 v39, v39
    v_pk_mul_f32 v[36:37], v[36:37], v[116:117]
    v_pk_mul_f32 v[38:39], v[38:39], v[118:119]
    v_cvt_pk_bf16_f32 v114, v36, v37
    v_cvt_pk_bf16_f32 v115, v38, v39
    buffer_load_dwordx4 v14, s[20:23], s83 offen offset:2048 lds
    v_pk_mul_f32 v[36:37], v[120:121], v[120:121]
    v_pk_fma_f32 v[36:37], v[36:37], s[26:27], v[4:5] op_sel_hi:[1,1,0]
    v_pk_mul_f32 v[36:37], v[36:37], v[120:121]
    v_pk_mul_f32 v[38:39], v[122:123], v[122:123]
    v_pk_fma_f32 v[38:39], v[38:39], s[26:27], v[4:5] op_sel_hi:[1,1,0]
    v_pk_mul_f32 v[38:39], v[38:39], v[122:123]
    v_exp_f32 v36, v36
    v_exp_f32 v37, v37
    v_exp_f32 v38, v38
    buffer_store_dwordx4 v[112:115], v1, s[28:31], s1 offen offset:0 sc1
    s_waitcnt vmcnt(9)
    ds_read_b64_tr_b16 a[112:113], v16 offset:53248
    ds_read_b64_tr_b16 a[114:115], v16 offset:54272
    ds_read_b64_tr_b16 a[116:117], v17 offset:53248
    ds_read_b64_tr_b16 a[118:119], v17 offset:54272
    v_exp_f32 v39, v39
    v_pk_add_f32 v[36:37], v[36:37], 1.0 op_sel_hi:[1,0]
    v_pk_add_f32 v[38:39], v[38:39], 1.0 op_sel_hi:[1,0]
    v_rcp_f32 v36, v36
    v_rcp_f32 v37, v37
    v_rcp_f32 v38, v38
    v_rcp_f32 v39, v39
    v_pk_mul_f32 v[36:37], v[36:37], v[120:121]
    v_pk_mul_f32 v[38:39], v[38:39], v[122:123]
    v_cvt_pk_bf16_f32 v116, v36, v37
    buffer_load_dwordx4 v15, s[20:23], s83 offen offset:3072 lds
    ds_read_b64_tr_b16 a[120:121], v16 offset:55296
    ds_read_b64_tr_b16 a[122:123], v16 offset:56320
    ds_read_b64_tr_b16 a[124:125], v17 offset:55296
    ds_read_b64_tr_b16 a[126:127], v17 offset:56320
    v_cvt_pk_bf16_f32 v117, v38, v39
    v_cmp_ne_u32 vcc, v2, v20
    s_nop 0
    s_cbranch_vccnz L_slow13
L_back13:
    v_pk_mul_f32 v[36:37], v[124:125], v[124:125]
    v_pk_fma_f32 v[36:37], v[36:37], s[26:27], v[4:5] op_sel_hi:[1,1,0]
    v_pk_mul_f32 v[36:37], v[36:37], v[124:125]
    v_pk_mul_f32 v[38:39], v[126:127], v[126:127]
    v_pk_fma_f32 v[38:39], v[38:39], s[26:27], v[4:5] op_sel_hi:[1,1,0]
    v_pk_mul_f32 v[38:39], v[38:39], v[126:127]
    v_exp_f32 v36, v36
    v_exp_f32 v37, v37
    v_exp_f32 v38, v38
    v_exp_f32 v39, v39
    v_pk_add_f32 v[36:37], v[36:37], 1.0 op_sel_hi:[1,0]
    v_pk_add_f32 v[38:39], v[38:39], 1.0 op_sel_hi:[1,0]
    v_rcp_f32 v36, v36
    v_rcp_f32 v37, v37
    v_rcp_f32 v38, v38
    v_rcp_f32 v39, v39
    v_pk_mul_f32 v[36:37], v[36:37], v[124:125]
    v_pk_mul_f32 v[38:39], v[38:39], v[126:127]
    v_cvt_pk_bf16_f32 v118, v36, v37
    v_cvt_pk_bf16_f32 v119, v38, v39
    s_add_u32 m0, s37, 106496
    s_add_u32 s75, s36, 2097152
    s_cmp_lt_i32 s87, 0
    s_cselect_b32 s75, 1073741824, s75
    buffer_load_dwordx4 v1, s[28:31], s75 offen sc1 lds
    s_waitcnt vmcnt(6)
    ds_read_b64_tr_b16 a[128:129], v16 offset:57344
    ds_read_b64_tr_b16 a[130:131], v16 offset:58368
    ds_read_b64_tr_b16 a[132:133], v17 offset:57344
    ds_read_b64_tr_b16 a[134:135], v17 offset:58368
    v_pk_mul_f32 v[36:37], v[128:129], v[128:129]
    v_pk_fma_f32 v[36:37], v[36:37], s[26:27], v[4:5] op_sel_hi:[1,1,0]
    v_pk_mul_f32 v[36:37], v[36:37], v[128:129]
    v_pk_mul_f32 v[38:39], v[130:131], v[130:131]
    v_pk_fma_f32 v[38:39], v[38:39], s[26:27], v[4:5] op_sel_hi:[1,1,0]
    v_pk_mul_f32 v[38:39], v[38:39], v[130:131]
    v_exp_f32 v36, v36
    v_exp_f32 v37, v37
    v_exp_f32 v38, v38
    buffer_load_dwordx4 v1, s[28:31], s75 offen offset:1024 sc1 lds
    ds_read_b64_tr_b16 a[136:137], v16 offset:59392
    ds_read_b64_tr_b16 a[138:139], v16 offset:60416
    ds_read_b64_tr_b16 a[140:141], v17 offset:59392
    ds_read_b64_tr_b16 a[142:143], v17 offset:60416
    v_exp_f32 v39, v39
    v_pk_add_f32 v[36:37], v[36:37], 1.0 op_sel_hi:[1,0]
    v_pk_add_f32 v[38:39], v[38:39], 1.0 op_sel_hi:[1,0]
    v_rcp_f32 v36, v36
    v_rcp_f32 v37, v37
    v_rcp_f32 v38, v38
    v_rcp_f32 v39, v39
    v_pk_mul_f32 v[36:37], v[36:37], v[128:129]
    v_pk_mul_f32 v[38:39], v[38:39], v[130:131]
    v_cvt_pk_bf16_f32 v120, v36, v37
    s_add_u32 m0, s37, 131072
    s_add_u32 s75, s75, 2097152
    buffer_load_dwordx4 v1, s[28:31], s75 offen sc1 lds
    v_cvt_pk_bf16_f32 v121, v38, v39
    v_pk_mul_f32 v[36:37], v[132:133], v[132:133]
    v_pk_fma_f32 v[36:37], v[36:37], s[26:27], v[4:5] op_sel_hi:[1,1,0]
    v_pk_mul_f32 v[36:37], v[36:37], v[132:133]
    v_pk_mul_f32 v[38:39], v[134:135], v[134:135]
    v_pk_fma_f32 v[38:39], v[38:39], s[26:27], v[4:5] op_sel_hi:[1,1,0]
    v_pk_mul_f32 v[38:39], v[38:39], v[134:135]
    v_exp_f32 v36, v36
    v_exp_f32 v37, v37
    v_exp_f32 v38, v38
    buffer_load_dwordx4 v1, s[28:31], s75 offen offset:1024 sc1 lds
    v_exp_f32 v39, v39
    v_pk_add_f32 v[36:37], v[36:37], 1.0 op_sel_hi:[1,0]
    v_pk_add_f32 v[38:39], v[38:39], 1.0 op_sel_hi:[1,0]
    v_rcp_f32 v36, v36
    v_rcp_f32 v37, v37
    v_rcp_f32 v38, v38
    v_rcp_f32 v39, v39
    v_pk_mul_f32 v[36:37], v[36:37], v[132:133]
    v_pk_mul_f32 v[38:39], v[38:39], v[134:135]
    v_cvt_pk_bf16_f32 v122, v36, v37
    s_add_u32 m0, s37, 108544
    s_add_u32 s75, s36, 2099200
    s_cmp_lt_i32 s87, -1
    s_cselect_b32 s75, 1073741824, s75
    buffer_load_dwordx4 v1, s[28:31], s75 offen sc1 lds
    v_cvt_pk_bf16_f32 v123, v38, v39
    v_pk_mul_f32 v[36:37], v[136:137], v[136:137]
    v_pk_fma_f32 v[36:37], v[36:37], s[26:27], v[4:5] op_sel_hi:[1,1,0]
    v_pk_mul_f32 v[36:37], v[36:37], v[136:137]
    v_pk_mul_f32 v[38:39], v[138:139], v[138:139]
    v_pk_fma_f32 v[38:39], v[38:39], s[26:27], v[4:5] op_sel_hi:[1,1,0]
    v_pk_mul_f32 v[38:39], v[38:39], v[138:139]
    v_exp_f32 v36, v36
    v_exp_f32 v37, v37
    buffer_load_dwordx4 v1, s[28:31], s75 offen offset:1024 sc1 lds
    v_exp_f32 v38, v38
    v_exp_f32 v39, v39
    v_pk_add_f32 v[36:37], v[36:37], 1.0 op_sel_hi:[1,0]
    v_pk_add_f32 v[38:39], v[38:39], 1.0 op_sel_hi:[1,0]
    v_rcp_f32 v36, v36
    v_rcp_f32 v37, v37
    v_rcp_f32 v38, v38
    v_rcp_f32 v39, v39
    v_pk_mul_f32 v[36:37], v[36:37], v[136:137]
    v_pk_mul_f32 v[38:39], v[38:39], v[138:139]
    s_add_u32 m0, s37, 133120
    s_add_u32 s75, s75, 2097152
    buffer_load_dwordx4 v1, s[28:31], s75 offen sc1 lds
    v_cvt_pk_bf16_f32 v124, v36, v37
    v_cvt_pk_bf16_f32 v125, v38, v39
    v_pk_mul_f32 v[36:37], v[140:141], v[140:141]
    v_pk_fma_f32 v[36:37], v[36:37], s[26:27], v[4:5] op_sel_hi:[1,1,0]
    v_pk_mul_f32 v[36:37], v[36:37], v[140:141]
    v_pk_mul_f32 v[38:39], v[142:143], v[142:143]
    v_pk_fma_f32 v[38:39], v[38:39], s[26:27], v[4:5] op_sel_hi:[1,1,0]
    v_pk_mul_f32 v[38:39], v[38:39], v[142:143]
    v_exp_f32 v36, v36
    v_exp_f32 v37, v37
    buffer_load_dwordx4 v1, s[28:31], s75 offen offset:1024 sc1 lds
    s_waitcnt vmcnt(8)
    ds_read_b64_tr_b16 a[144:145], v16 offset:0
    ds_read_b64_tr_b16 a[146:147], v16 offset:1024
    ds_read_b64_tr_b16 a[148:149], v17 offset:0
    ds_read_b64_tr_b16 a[150:151], v17 offset:1024
    v_exp_f32 v38, v38
    v_exp_f32 v39, v39
    v_pk_add_f32 v[36:37], v[36:37], 1.0 op_sel_hi:[1,0]
    v_pk_add_f32 v[38:39], v[38:39], 1.0 op_sel_hi:[1,0]
    v_rcp_f32 v36, v36
    v_rcp_f32 v37, v37
    v_rcp_f32 v38, v38
    v_rcp_f32 v39, v39
    v_pk_mul_f32 v[36:37], v[36:37], v[140:141]
    v_pk_mul_f32 v[38:39], v[38:39], v[142:143]
    s_add_u32 m0, s37, 110592
    s_add_u32 s75, s36, 2101248
    s_cmp_lt_i32 s87, -2
    s_cselect_b32 s75, 1073741824, s75
    buffer_load_dwordx4 v1, s[28:31], s75 offen sc1 lds
    ds_read_b64_tr_b16 a[152:153], v16 offset:2048
    ds_read_b64_tr_b16 a[154:155], v16 offset:3072
    ds_read_b64_tr_b16 a[156:157], v17 offset:2048
    ds_read_b64_tr_b16 a[158:159], v17 offset:3072
    v_cvt_pk_bf16_f32 v126, v36, v37
    v_cvt_pk_bf16_f32 v127, v38, v39
    v_pk_mul_f32 v[36:37], v[64:65], v[64:65]
    v_pk_fma_f32 v[36:37], v[36:37], s[26:27], v[4:5] op_sel_hi:[1,1,0]
    v_pk_mul_f32 v[36:37], v[36:37], v[64:65]
    v_pk_mul_f32 v[38:39], v[66:67], v[66:67]
    v_pk_fma_f32 v[38:39], v[38:39], s[26:27], v[4:5] op_sel_hi:[1,1,0]
    v_pk_mul_f32 v[38:39], v[38:39], v[66:67]
    v_exp_f32 v36, v36
    buffer_load_dwordx4 v1, s[28:31], s75 offen offset:1024 sc1 lds
    v_exp_f32 v37, v37
    v_exp_f32 v38, v38
    v_exp_f32 v39, v39
    v_pk_add_f32 v[36:37], v[36:37], 1.0 op_sel_hi:[1,0]
    v_pk_add_f32 v[38:39], v[38:39], 1.0 op_sel_hi:[1,0]
    v_rcp_f32 v36, v36
    v_rcp_f32 v37, v37
    v_rcp_f32 v38, v38
    v_rcp_f32 v39, v39
    v_pk_mul_f32 v[36:37], v[36:37], v[64:65]
    s_add_u32 m0, s37, 135168
    s_add_u32 s75, s75, 2097152
    buffer_load_dwordx4 v1, s[28:31], s75 offen sc1 lds
    v_pk_mul_f32 v[38:39], v[38:39], v[66:67]
    v_cvt_pk_bf16_f32 v64, v36, v37
    v_cvt_pk_bf16_f32 v65, v38, v39
    v_pk_mul_f32 v[36:37], v[68:69], v[68:69]
    v_pk_fma_f32 v[36:37], v[36:37], s[26:27], v[4:5] op_sel_hi:[1,1,0]
    v_pk_mul_f32 v[36:37], v[36:37], v[68:69]
    v_pk_mul_f32 v[38:39], v[70:71], v[70:71]
    v_pk_fma_f32 v[38:39], v[38:39], s[26:27], v[4:5] op_sel_hi:[1,1,0]
    v_pk_mul_f32 v[38:39], v[38:39], v[70:71]
    v_exp_f32 v36, v36
    buffer_load_dwordx4 v1, s[28:31], s75 offen offset:1024 sc1 lds
    v_exp_f32 v37, v37
    v_exp_f32 v38, v38
    v_exp_f32 v39, v39
    v_pk_add_f32 v[36:37], v[36:37], 1.0 op_sel_hi:[1,0]
    v_pk_add_f32 v[38:39], v[38:39], 1.0 op_sel_hi:[1,0]
    v_rcp_f32 v36, v36
    v_rcp_f32 v37, v37
    v_rcp_f32 v38, v38
    v_rcp_f32 v39, v39
    v_pk_mul_f32 v[36:37], v[36:37], v[68:69]
    buffer_load_dwordx4 v[96:99], v1, s[28:31], s38 offen offset:0 sc1
    v_pk_mul_f32 v[38:39], v[38:39], v[70:71]
    v_cvt_pk_bf16_f32 v66, v36, v37
    v_cvt_pk_bf16_f32 v67, v38, v39
    v_pk_mul_f32 v[36:37], v[72:73], v[72:73]
    v_pk_fma_f32 v[36:37], v[36:37], s[26:27], v[4:5] op_sel_hi:[1,1,0]
    v_pk_mul_f32 v[36:37], v[36:37], v[72:73]
    v_pk_mul_f32 v[38:39], v[74:75], v[74:75]
    v_pk_fma_f32 v[38:39], v[38:39], s[26:27], v[4:5] op_sel_hi:[1,1,0]
    v_pk_mul_f32 v[38:39], v[38:39], v[74:75]
    buffer_load_dwordx4 v[100:103], v1, s[28:31], s38 offen offset:1024 sc1
    v_exp_f32 v36, v36
    v_exp_f32 v37, v37
    v_exp_f32 v38, v38
    v_exp_f32 v39, v39
    v_pk_add_f32 v[36:37], v[36:37], 1.0 op_sel_hi:[1,0]
    v_pk_add_f32 v[38:39], v[38:39], 1.0 op_sel_hi:[1,0]
    v_rcp_f32 v36, v36
    v_rcp_f32 v37, v37
    v_rcp_f32 v38, v38
    v_rcp_f32 v39, v39
    buffer_store_dwordx4 v[116:119], v1, s[28:31], s1 offen offset:1024 sc1
    v_pk_mul_f32 v[36:37], v[36:37], v[72:73]
    v_pk_mul_f32 v[38:39], v[38:39], v[74:75]
    v_cvt_pk_bf16_f32 v68, v36, v37
    v_cvt_pk_bf16_f32 v69, v38, v39
    v_pk_mul_f32 v[36:37], v[76:77], v[76:77]
    v_pk_fma_f32 v[36:37], v[36:37], s[26:27], v[4:5] op_sel_hi:[1,1,0]
    v_pk_mul_f32 v[36:37], v[36:37], v[76:77]
    v_pk_mul_f32 v[38:39], v[78:79], v[78:79]
    v_pk_fma_f32 v[38:39], v[38:39], s[26:27], v[4:5] op_sel_hi:[1,1,0]
    v_pk_mul_f32 v[38:39], v[38:39], v[78:79]
    buffer_store_dwordx4 v[120:123], v1, s[28:31], s1 offen offset:2048 sc1
    v_exp_f32 v36, v36
    v_exp_f32 v37, v37
    v_exp_f32 v38, v38
    v_exp_f32 v39, v39
    v_pk_add_f32 v[36:37], v[36:37], 1.0 op_sel_hi:[1,0]
    v_pk_add_f32 v[38:39], v[38:39], 1.0 op_sel_hi:[1,0]
    v_rcp_f32 v36, v36
    v_rcp_f32 v37, v37
    v_rcp_f32 v38, v38
    v_rcp_f32 v39, v39
    v_pk_mul_f32 v[36:37], v[36:37], v[76:77]
    v_pk_mul_f32 v[38:39], v[38:39], v[78:79]
    v_cvt_pk_bf16_f32 v70, v36, v37
    v_cvt_pk_bf16_f32 v71, v38, v39
    v_pk_mul_f32 v[36:37], v[80:81], v[80:81]
    v_pk_fma_f32 v[36:37], v[36:37], s[26:27], v[4:5] op_sel_hi:[1,1,0]
    v_pk_mul_f32 v[36:37], v[36:37], v[80:81]
    v_pk_mul_f32 v[38:39], v[82:83], v[82:83]
    v_pk_fma_f32 v[38:39], v[38:39], s[26:27], v[4:5] op_sel_hi:[1,1,0]
    v_pk_mul_f32 v[38:39], v[38:39], v[82:83]
    v_exp_f32 v36, v36
    v_exp_f32 v37, v37
    v_exp_f32 v38, v38
    v_exp_f32 v39, v39
    v_pk_add_f32 v[36:37], v[36:37], 1.0 op_sel_hi:[1,0]
    v_pk_add_f32 v[38:39], v[38:39], 1.0 op_sel_hi:[1,0]
    v_rcp_f32 v36, v36
    v_rcp_f32 v37, v37
    v_rcp_f32 v38, v38
    buffer_store_dwordx4 v[124:127], v1, s[28:31], s1 offen offset:3072 sc1
    v_rcp_f32 v39, v39
    v_pk_mul_f32 v[36:37], v[36:37], v[80:81]
    v_pk_mul_f32 v[38:39], v[38:39], v[82:83]
    v_cvt_pk_bf16_f32 v72, v36, v37
    v_cvt_pk_bf16_f32 v73, v38, v39
    v_pk_mul_f32 v[36:37], v[84:85], v[84:85]
    v_pk_fma_f32 v[36:37], v[36:37], s[26:27], v[4:5] op_sel_hi:[1,1,0]
    v_pk_mul_f32 v[36:37], v[36:37], v[84:85]
    v_pk_mul_f32 v[38:39], v[86:87], v[86:87]
    v_pk_fma_f32 v[38:39], v[38:39], s[26:27], v[4:5] op_sel_hi:[1,1,0]
    v_pk_mul_f32 v[38:39], v[38:39], v[86:87]
    v_exp_f32 v36, v36
    v_exp_f32 v37, v37
    v_exp_f32 v38, v38
    v_exp_f32 v39, v39
    v_pk_add_f32 v[36:37], v[36:37], 1.0 op_sel_hi:[1,0]
    v_pk_add_f32 v[38:39], v[38:39], 1.0 op_sel_hi:[1,0]
    v_rcp_f32 v36, v36
    v_rcp_f32 v37, v37
    v_rcp_f32 v38, v38
    v_rcp_f32 v39, v39
    v_pk_mul_f32 v[36:37], v[36:37], v[84:85]
    v_pk_mul_f32 v[38:39], v[38:39], v[86:87]
    v_cvt_pk_bf16_f32 v74, v36, v37
    v_cvt_pk_bf16_f32 v75, v38, v39
    v_pk_mul_f32 v[36:37], v[88:89], v[88:89]
    v_pk_fma_f32 v[36:37], v[36:37], s[26:27], v[4:5] op_sel_hi:[1,1,0]
    v_pk_mul_f32 v[36:37], v[36:37], v[88:89]
    v_pk_mul_f32 v[38:39], v[90:91], v[90:91]
    buffer_store_dwordx4 v[64:67], v1, s[28:31], s4 offen offset:0 sc1
    v_pk_fma_f32 v[38:39], v[38:39], s[26:27], v[4:5] op_sel_hi:[1,1,0]
    v_pk_mul_f32 v[38:39], v[38:39], v[90:91]
    v_exp_f32 v36, v36
    v_exp_f32 v37, v37
    v_exp_f32 v38, v38
    v_exp_f32 v39, v39
    v_pk_add_f32 v[36:37], v[36:37], 1.0 op_sel_hi:[1,0]
    v_pk_add_f32 v[38:39], v[38:39], 1.0 op_sel_hi:[1,0]
    v_rcp_f32 v36, v36
    v_rcp_f32 v37, v37
    v_rcp_f32 v38, v38
    v_rcp_f32 v39, v39
    v_pk_mul_f32 v[36:37], v[36:37], v[88:89]
    v_pk_mul_f32 v[38:39], v[38:39], v[90:91]
    v_cvt_pk_bf16_f32 v76, v36, v37
    v_cvt_pk_bf16_f32 v77, v38, v39
    v_pk_mul_f32 v[36:37], v[92:93], v[92:93]
    v_pk_fma_f32 v[36:37], v[36:37], s[26:27], v[4:5] op_sel_hi:[1,1,0]
    v_pk_mul_f32 v[36:37], v[36:37], v[92:93]
    v_pk_mul_f32 v[38:39], v[94:95], v[94:95]
    v_pk_fma_f32 v[38:39], v[38:39], s[26:27], v[4:5] op_sel_hi:[1,1,0]
    v_pk_mul_f32 v[38:39], v[38:39], v[94:95]
    v_exp_f32 v36, v36
    v_exp_f32 v37, v37
    v_exp_f32 v38, v38
    v_exp_f32 v39, v39
    v_pk_add_f32 v[36:37], v[36:37], 1.0 op_sel_hi:[1,0]
    v_pk_add_f32 v[38:39], v[38:39], 1.0 op_sel_hi:[1,0]
    v_rcp_f32 v36, v36
    v_rcp_f32 v37, v37
    buffer_store_dwordx4 v[68:71], v1, s[28:31], s4 offen offset:1024 sc1
    v_rcp_f32 v38, v38
    v_rcp_f32 v39, v39
    v_pk_mul_f32 v[36:37], v[36:37], v[92:93]
    v_pk_mul_f32 v[38:39], v[38:39], v[94:95]
    v_cvt_pk_bf16_f32 v78, v36, v37
    v_cvt_pk_bf16_f32 v79, v38, v39
    v_and_b32 v26, 31, v0
    v_lshrrev_b32 v27, 5, v0
    v_lshlrev_b32 v28, 2, v27
    v_sub_u32 v26, v26, v28
    s_cmp_gt_u32 s59, 0
    s_cselect_b32 s60, 4286578688, 0
    v_mov_b32 v28, s60
    v_mov_b32 v29, 4286578688
    s_cmp_gt_u32 s59, 1
    s_cselect_b32 s60, 4286578688, 0
    v_cmp_le_i32 s[66:67], 0, v26
    v_cmp_le_i32 s[88:89], 1, v26
    v_mov_b32 v176, s60
    v_mov_b32 v177, s60
    v_cndmask_b32 v208, v29, 0, s[66:67]
    v_cndmask_b32 v192, v28, v29, s[66:67]
    v_cndmask_b32 v209, v29, 0, s[88:89]
    v_cndmask_b32 v193, v28, v29, s[88:89]
    v_cmp_le_i32 s[66:67], 2, v26
    v_cmp_le_i32 s[88:89], 3, v26
    v_mov_b32 v178, s60
    v_mov_b32 v179, s60
    v_cndmask_b32 v210, v29, 0, s[66:67]
    v_cndmask_b32 v194, v28, v29, s[66:67]
    buffer_store_dwordx4 v[72:75], v1, s[28:31], s4 offen offset:2048 sc1
    v_cndmask_b32 v211, v29, 0, s[88:89]
    v_cndmask_b32 v195, v28, v29, s[88:89]
    v_cmp_le_i32 s[66:67], 8, v26
    v_cmp_le_i32 s[88:89], 9, v26
    v_mov_b32 v180, s60
    v_mov_b32 v181, s60
    v_cndmask_b32 v212, v29, 0, s[66:67]
    v_cndmask_b32 v196, v28, v29, s[66:67]
    v_cndmask_b32 v213, v29, 0, s[88:89]
    v_cndmask_b32 v197, v28, v29, s[88:89]
    v_cmp_le_i32 s[66:67], 10, v26
    v_cmp_le_i32 s[88:89], 11, v26
    v_mov_b32 v182, s60
    v_mov_b32 v183, s60
    v_cndmask_b32 v214, v29, 0, s[66:67]
    v_cndmask_b32 v198, v28, v29, s[66:67]
    v_cndmask_b32 v215, v29, 0, s[88:89]
    v_cndmask_b32 v199, v28, v29, s[88:89]
    v_cmp_le_i32 s[66:67], 16, v26
    v_cmp_le_i32 s[88:89], 17, v26
    v_mov_b32 v184, s60
    v_mov_b32 v185, s60
    v_cndmask_b32 v216, v29, 0, s[66:67]
    v_cndmask_b32 v200, v28, v29, s[66:67]
    v_cndmask_b32 v217, v29, 0, s[88:89]
    v_cndmask_b32 v201, v28, v29, s[88:89]
    v_cmp_le_i32 s[66:67], 18, v26
    v_cmp_le_i32 s[88:89], 19, v26
    v_mov_b32 v186, s60
    v_mov_b32 v187, s60
    v_cndmask_b32 v218, v29, 0, s[66:67]
    v_cndmask_b32 v202, v28, v29, s[66:67]
    v_cndmask_b32 v219, v29, 0, s[88:89]
    v_cndmask_b32 v203, v28, v29, s[88:89]
    v_cmp_le_i32 s[66:67], 24, v26
    v_cmp_le_i32 s[88:89], 25, v26
    v_mov_b32 v188, s60
    v_mov_b32 v189, s60
    v_cndmask_b32 v220, v29, 0, s[66:67]
    v_cndmask_b32 v204, v28, v29, s[66:67]
    v_cndmask_b32 v221, v29, 0, s[88:89]
    buffer_store_dwordx4 v[76:79], v1, s[28:31], s4 offen offset:3072 sc1
    v_cndmask_b32 v205, v28, v29, s[88:89]
    v_cmp_le_i32 s[66:67], 26, v26
    v_cmp_le_i32 s[88:89], 27, v26
    v_mov_b32 v190, s60
    v_mov_b32 v191, s60
    v_cndmask_b32 v222, v29, 0, s[66:67]
    v_cndmask_b32 v206, v28, v29, s[66:67]
    v_cndmask_b32 v223, v29, 0, s[88:89]
    v_cndmask_b32 v207, v28, v29, s[88:89]
    s_lshl_b32 s61, s48, 11
    s_add_u32 s61, s61, 106496
    v_add_u32 v6, s61, v1
    v_mov_b32 v248, 4286578688
    v_mov_b32 v249, 4286578688
    v_add_u32 v8, 114688, v1
    v_mov_b32 v255, 4286578688
    s_waitcnt vmcnt(7)
    s_barrier
    ds_read_b128 v[40:43], v6 offset:0
    ds_read_b128 v[44:47], v6 offset:1024
    ds_read_b128 v[48:51], v6 offset:2048
    ds_read_b128 v[52:55], v6 offset:3072
    s_waitcnt lgkmcnt(3)
    v_mfma_f32_32x32x16_bf16 v[144:159], v[40:43], v[96:99], v[192:207]
    ds_read_b128 v[56:59], v6 offset:4096
    ds_read_b128 v[60:63], v6 offset:5120
    s_waitcnt lgkmcnt(4)
    v_mfma_f32_32x32x16_bf16 v[144:159], v[44:47], v[100:103], v[144:159]
    s_add_u32 m0, s82, 4096
    s_add_u32 s83, s83, s77
    buffer_load_dwordx4 v12, s[20:23], s83 offen lds
    s_waitcnt lgkmcnt(3)
    v_mfma_f32_32x32x16_bf16 v[160:175], v[48:51], v[96:99], v[176:191]
    ds_read_b128 v[40:43], v6 offset:6144
    ds_read_b128 v[44:47], v6 offset:7168
    s_waitcnt lgkmcnt(4)
    v_mfma_f32_32x32x16_bf16 v[160:175], v[52:55], v[100:103], v[160:175]
    s_nop 2
    v_max3_f32 v248, v144, v145, v248
    v_max3_f32 v249, v146, v147, v249
    v_max3_f32 v248, v148, v149, v248
    v_max3_f32 v249, v150, v151, v249
    v_max3_f32 v248, v152, v153, v248
    v_max3_f32 v249, v154, v155, v249
    v_max3_f32 v248, v156, v157, v248
    v_max3_f32 v249, v158, v159, v249
    s_cmp_eq_u32 s59, 2
    s_cbranch_scc1 L_pat14
L_patb14:
    s_waitcnt lgkmcnt(3)
    v_mfma_f32_32x32x16_bf16 v[144:159], v[56:59], v[96:99], v[176:191]
    ds_read_b128 v[48:51], v6 offset:8192
    ds_read_b128 v[52:55], v6 offset:9216
    s_waitcnt lgkmcnt(4)
    v_mfma_f32_32x32x16_bf16 v[144:159], v[60:63], v[100:103], v[144:159]
    buffer_load_dwordx4 v13, s[20:23], s83 offen offset:1024 lds
    v_max3_f32 v248, v160, v161, v248
    v_max3_f32 v249, v162, v163, v249
    v_max3_f32 v248, v164, v165, v248
    v_max3_f32 v249, v166, v167, v249
    v_max3_f32 v248, v168, v169, v248
    v_max3_f32 v249, v170, v171, v249
    v_max3_f32 v248, v172, v173, v248
    v_max3_f32 v249, v174, v175, v249
    s_cmp_eq_u32 s59, 3
    s_cbranch_scc1 L_pat15
L_patb15:
    s_waitcnt lgkmcnt(3)
    v_mfma_f32_32x32x16_bf16 v[160:175], v[40:43], v[96:99], v[176:191]
    ds_read_b128 v[56:59], v6 offset:10240
    ds_read_b128 v[60:63], v6 offset:11264
    s_waitcnt lgkmcnt(4)
    v_mfma_f32_32x32x16_bf16 v[160:175], v[44:47], v[100:103], v[160:175]
    buffer_load_dwordx4 v14, s[20:23], s83 offen offset:2048 lds
    v_max3_f32 v248, v144, v145, v248
    v_max3_f32 v249, v146, v147, v249
    v_max3_f32 v248, v148, v149, v248
    v_max3_f32 v249, v150, v151, v249
    v_max3_f32 v248, v152, v153, v248
    v_max3_f32 v249, v154, v155, v249
    v_max3_f32 v248, v156, v157, v248
    v_max3_f32 v249, v158, v159, v249
    s_cmp_eq_u32 s59, 4
    s_cbranch_scc1 L_pat16
L_patb16:
    s_waitcnt lgkmcnt(3)
    v_mfma_f32_32x32x16_bf16 v[144:159], v[48:51], v[96:99], v[176:191]
    ds_read_b128 v[40:43], v6 offset:12288
    ds_read_b128 v[44:47], v6 offset:13312
    s_waitcnt lgkmcnt(4)
    v_mfma_f32_32x32x16_bf16 v[144:159], v[52:55], v[100:103], v[144:159]
    buffer_load_dwordx4 v15, s[20:23], s83 offen offset:3072 lds
    v_max3_f32 v248, v160, v161, v248
    v_max3_f32 v249, v162, v163, v249
    v_max3_f32 v248, v164, v165, v248
    v_max3_f32 v249, v166, v167, v249
    v_max3_f32 v248, v168, v169, v248
    v_max3_f32 v249, v170, v171, v249
    v_max3_f32 v248, v172, v173, v248
    v_max3_f32 v249, v174, v175, v249
    s_cmp_eq_u32 s59, 5
    s_cbranch_scc1 L_pat17
L_patb17:
    s_waitcnt lgkmcnt(3)
    v_mfma_f32_32x32x16_bf16 v[160:175], v[56:59], v[96:99], v[176:191]
    ds_read_b128 v[48:51], v6 offset:14336
    ds_read_b128 v[52:55], v6 offset:15360
    s_waitcnt lgkmcnt(4)
    v_mfma_f32_32x32x16_bf16 v[160:175], v[60:63], v[100:103], v[160:175]
    s_add_u32 m0, s82, 8192
    s_add_u32 s83, s83, s77
    buffer_load_dwordx4 v12, s[20:23], s83 offen lds
    v_max3_f32 v248, v144, v145, v248
    v_max3_f32 v249, v146, v147, v249
    v_max3_f32 v248, v148, v149, v248
    v_max3_f32 v249, v150, v151, v249
    v_max3_f32 v248, v152, v153, v248
    v_max3_f32 v249, v154, v155, v249
    v_max3_f32 v248, v156, v157, v248
    v_max3_f32 v249, v158, v159, v249
    s_cmp_eq_u32 s59, 6
    s_cbranch_scc1 L_pat18
L_patb18:
    s_waitcnt lgkmcnt(3)
    v_mfma_f32_32x32x16_bf16 v[144:159], v[40:43], v[96:99], v[176:191]
    ds_read_b128 v[56:59], v6 offset:16384
    ds_read_b128 v[60:63], v6 offset:17408
    s_waitcnt lgkmcnt(4)
    v_mfma_f32_32x32x16_bf16 v[144:159], v[44:47], v[100:103], v[144:159]
    buffer_load_dwordx4 v13, s[20:23], s83 offen offset:1024 lds
    v_max3_f32 v248, v160, v161, v248
    v_max3_f32 v249, v162, v163, v249
    v_max3_f32 v248, v164, v165, v248
    v_max3_f32 v249, v166, v167, v249
    v_max3_f32 v248, v168, v169, v248
    v_max3_f32 v249, v170, v171, v249
    v_max3_f32 v248, v172, v173, v248
    v_max3_f32 v249, v174, v175, v249
    s_cmp_eq_u32 s59, 7
    s_cbranch_scc1 L_pat19
L_patb19:
    s_waitcnt lgkmcnt(3)
    v_mfma_f32_32x32x16_bf16 v[160:175], v[48:51], v[96:99], v[176:191]
    ds_read_b128 v[40:43], v6 offset:0
    ds_read_b128 v[44:47], v6 offset:1024
    s_waitcnt lgkmcnt(4)
    v_mfma_f32_32x32x16_bf16 v[160:175], v[52:55], v[100:103], v[160:175]
    s_waitcnt vmcnt(6)
    s_add_u32 s63, s5, 131072
    buffer_store_dword v2, v3, s[28:31], s63 offen sc1
    v_max3_f32 v248, v144, v145, v248
    v_max3_f32 v249, v146, v147, v249
    v_max3_f32 v248, v148, v149, v248
    v_max3_f32 v249, v150, v151, v249
    v_max3_f32 v248, v152, v153, v248
    v_max3_f32 v249, v154, v155, v249
    v_max3_f32 v248, v156, v157, v248
    v_max3_f32 v249, v158, v159, v249
    s_waitcnt lgkmcnt(3)
    v_mfma_f32_32x32x16_bf16 v[144:159], v[56:59], v[96:99], v[208:223]
    ds_read_b128 v[48:51], v6 offset:2048
    ds_read_b128 v[52:55], v6 offset:3072
    s_waitcnt lgkmcnt(4)
    v_mfma_f32_32x32x16_bf16 v[144:159], v[60:63], v[100:103], v[144:159]
    buffer_load_dwordx4 v14, s[20:23], s83 offen offset:2048 lds
    v_max3_f32 v248, v160, v161, v248
    v_max3_f32 v249, v162, v163, v249
    v_max3_f32 v248, v164, v165, v248
    v_max3_f32 v249, v166, v167, v249
    v_max3_f32 v248, v168, v169, v248
    v_max3_f32 v249, v170, v171, v249
    v_max3_f32 v248, v172, v173, v248
    v_max3_f32 v249, v174, v175, v249
    s_nop 2
    v_max3_f32 v248, v144, v145, v248
    v_max3_f32 v249, v146, v147, v249
    v_max3_f32 v248, v148, v149, v248
    v_max3_f32 v249, v150, v151, v249
    v_max3_f32 v248, v152, v153, v248
    v_max3_f32 v249, v154, v155, v249
    v_max3_f32 v248, v156, v157, v248
    v_max3_f32 v249, v158, v159, v249
    v_max_f32 v248, v248, v249
    buffer_load_dwordx4 v15, s[20:23], s83 offen offset:3072 lds
    v_mov_b32 v249, v248
    s_add_u32 m0, s82, 49152
    s_add_u32 s83, s83, s77
    buffer_load_dwordx4 v12, s[20:23], s83 offen lds
    v_permlane32_swap_b32 v248, v249
    v_max_f32 v248, v248, v249
    s_waitcnt vmcnt(6)
    ds_read_b64_tr_b16 a[160:161], v16 offset:4096
    ds_read_b64_tr_b16 a[162:163], v16 offset:5120
    v_cvt_pk_bf16_f32 v250, -v248, -v248
    ds_read_b64_tr_b16 a[164:165], v17 offset:4096
    ds_read_b64_tr_b16 a[166:167], v17 offset:5120
    v_lshlrev_b32 v250, 16, v250
    buffer_load_dwordx4 v13, s[20:23], s83 offen offset:1024 lds
    v_sub_f32 v250, -v248, v250
    ds_read_b64_tr_b16 a[168:169], v16 offset:6144
    ds_read_b64_tr_b16 a[170:171], v16 offset:7168
    v_cvt_pk_bf16_f32 v252, -v248, v250
    ds_read_b64_tr_b16 a[172:173], v17 offset:6144
    ds_read_b64_tr_b16 a[174:175], v17 offset:7168
    v_and_b32 v254, 0xffff0000, v252
    buffer_load_dwordx4 v14, s[20:23], s83 offen offset:2048 lds
    v_sub_f32 v250, v250, v254
    v_cndmask_b32 v102, v102, v252, s[64:65]
    v_cvt_pk_bf16_f32 v250, v250, 0
    v_cndmask_b32 v103, v103, v250, s[64:65]
    s_cmp_gt_u32 s59, 1
    s_cbranch_scc1 L_pat20
L_patb20:
    s_waitcnt lgkmcnt(11)
    v_mfma_f32_32x32x16_bf16 v[144:159], v[40:43], v[96:99], v[192:207]
    ds_read_b128 v[56:59], v6 offset:4096
    ds_read_b128 v[60:63], v6 offset:5120
    s_waitcnt lgkmcnt(12)
    v_mfma_f32_32x32x16_bf16 v[144:159], v[44:47], v[100:103], v[144:159]
    s_waitcnt lgkmcnt(11)
    v_mfma_f32_32x32x16_bf16 v[160:175], v[48:51], v[96:99], v[176:191]
    ds_read_b64_tr_b16 v[136:137], v11 offset:0
    ds_read_b64_tr_b16 v[138:139], v11 offset:256
    ds_read_b64_tr_b16 v[140:141], v11 offset:512
    ds_read_b64_tr_b16 v[142:143], v11 offset:768
    buffer_load_dwordx4 v15, s[20:23], s83 offen offset:3072 lds
    s_nop 4
    v_exp_f32 v144, v144
    v_exp_f32 v145, v145
    v_exp_f32 v146, v146
    v_exp_f32 v147, v147
    s_waitcnt lgkmcnt(14)
    v_mfma_f32_32x32x16_bf16 v[160:175], v[52:55], v[100:103], v[160:175]
    s_add_u32 m0, s82, 53248
    s_add_u32 s83, s83, s77
    buffer_load_dwordx4 v12, s[20:23], s83 offen lds
    v_exp_f32 v148, v148
    v_exp_f32 v149, v149
    v_exp_f32 v150, v150
    v_exp_f32 v151, v151
    v_exp_f32 v152, v152
    v_cvt_pk_bf16_f32 v240, v144, v145
    v_cvt_pk_bf16_f32 v241, v146, v147
    v_cvt_pk_bf16_f32 v242, v148, v149
    v_cvt_pk_bf16_f32 v243, v150, v151
    v_exp_f32 v153, v153
    v_exp_f32 v154, v154
    s_waitcnt lgkmcnt(2)
    v_mfma_f32_32x32x16_bf16 v[224:239], v[136:139], v[240:243], 0
    ds_read_b128 v[40:43], v6 offset:6144
    ds_read_b128 v[44:47], v6 offset:7168
    buffer_load_dwordx4 v13, s[20:23], s83 offen offset:1024 lds
    v_exp_f32 v155, v155
    v_exp_f32 v156, v156
    v_exp_f32 v157, v157
    v_exp_f32 v158, v158
    v_exp_f32 v159, v159
    v_cvt_pk_bf16_f32 v244, v152, v153
    v_cvt_pk_bf16_f32 v245, v154, v155
    v_cvt_pk_bf16_f32 v246, v156, v157
    v_cvt_pk_bf16_f32 v247, v158, v159
    buffer_load_dwordx4 v14, s[20:23], s83 offen offset:2048 lds
    s_waitcnt lgkmcnt(2)
    v_mfma_f32_32x32x16_bf16 v[224:239], v[140:143], v[244:247], v[224:239]
    s_cmp_eq_u32 s59, 2
    s_cbranch_scc1 L_pat21
L_patb21:
    v_mfma_f32_32x32x16_bf16 v[144:159], v[56:59], v[96:99], v[176:191]
    ds_read_b64_tr_b16 v[136:137], v11 offset:2048
    ds_read_b64_tr_b16 v[138:139], v11 offset:2304
    ds_read_b64_tr_b16 v[140:141], v11 offset:2560
    ds_read_b64_tr_b16 v[142:143], v11 offset:2816
    buffer_load_dwordx4 v15, s[20:23], s83 offen offset:3072 lds
    v_exp_f32 v160, v160
    v_exp_f32 v161, v161
    v_exp_f32 v162, v162
    v_exp_f32 v163, v163
    v_mfma_f32_32x32x16_bf16 v[144:159], v[60:63], v[100:103], v[144:159]
    s_add_u32 m0, s82, 57344
    s_nop 0
    buffer_load_dwordx4 v12, s[12:15], s84 offen lds
    s_waitcnt vmcnt(9)
    ds_read_b64_tr_b16 a[176:177], v16 offset:8192
    ds_read_b64_tr_b16 a[178:179], v16 offset:9216
    ds_read_b64_tr_b16 a[180:181], v17 offset:8192
    ds_read_b64_tr_b16 a[182:183], v17 offset:9216
    v_exp_f32 v164, v164
    v_exp_f32 v165, v165
    v_exp_f32 v166, v166
    v_exp_f32 v167, v167
    v_exp_f32 v168, v168
    v_cvt_pk_bf16_f32 v240, v160, v161
    v_cvt_pk_bf16_f32 v241, v162, v163
    v_cvt_pk_bf16_f32 v242, v164, v165
    v_cvt_pk_bf16_f32 v243, v166, v167
    v_exp_f32 v169, v169
    v_exp_f32 v170, v170
    s_waitcnt lgkmcnt(6)
    v_mfma_f32_32x32x16_bf16 v[224:239], v[136:139], v[240:243], v[224:239]
    ds_read_b128 v[48:51], v6 offset:8192
    ds_read_b128 v[52:55], v6 offset:9216
    buffer_load_dwordx4 v13, s[12:15], s84 offen offset:1024 lds
    ds_read_b64_tr_b16 a[184:185], v16 offset:10240
    ds_read_b64_tr_b16 a[186:187], v16 offset:11264
    v_exp_f32 v171, v171
    v_exp_f32 v172, v172
    v_exp_f32 v173, v173
    v_exp_f32 v174, v174
    v_exp_f32 v175, v175
    v_cvt_pk_bf16_f32 v244, v168, v169
    v_cvt_pk_bf16_f32 v245, v170, v171
    v_cvt_pk_bf16_f32 v246, v172, v173
    v_cvt_pk_bf16_f32 v247, v174, v175
    buffer_load_dwordx4 v14, s[12:15], s84 offen offset:2048 lds
    ds_read_b64_tr_b16 a[188:189], v17 offset:10240
    ds_read_b64_tr_b16 a[190:191], v17 offset:11264
    s_waitcnt lgkmcnt(10)
    v_mfma_f32_32x32x16_bf16 v[224:239], v[140:143], v[244:247], v[224:239]
    s_cmp_eq_u32 s59, 3
    s_cbranch_scc1 L_pat22
L_patb22:
    v_mfma_f32_32x32x16_bf16 v[160:175], v[40:43], v[96:99], v[176:191]
    ds_read_b64_tr_b16 v[136:137], v11 offset:4096
    ds_read_b64_tr_b16 v[138:139], v11 offset:4352
    ds_read_b64_tr_b16 v[140:141], v11 offset:4608
    ds_read_b64_tr_b16 v[142:143], v11 offset:4864
    buffer_load_dwordx4 v15, s[12:15], s84 offen offset:3072 lds
    v_exp_f32 v144, v144
    v_exp_f32 v145, v145
    v_exp_f32 v146, v146
    v_exp_f32 v147, v147
    v_mfma_f32_32x32x16_bf16 v[160:175], v[44:47], v[100:103], v[160:175]
    s_mov_b32 m0, s82
    s_add_u32 s84, s84, 25088
    buffer_load_dwordx4 v12, s[12:15], s84 offen lds
    v_exp_f32 v148, v148
    v_exp_f32 v149, v149
    v_exp_f32 v150, v150
    v_exp_f32 v151, v151
    v_exp_f32 v152, v152
    v_cvt_pk_bf16_f32 v240, v144, v145
    v_cvt_pk_bf16_f32 v241, v146, v147
    v_cvt_pk_bf16_f32 v242, v148, v149
    v_cvt_pk_bf16_f32 v243, v150, v151
    v_exp_f32 v153, v153
    v_exp_f32 v154, v154
    s_waitcnt lgkmcnt(2)
    v_mfma_f32_32x32x16_bf16 v[224:239], v[136:139], v[240:243], v[224:239]
    ds_read_b128 v[56:59], v6 offset:10240
    ds_read_b128 v[60:63], v6 offset:11264
    buffer_load_dwordx4 v13, s[12:15], s84 offen offset:1024 lds
    v_exp_f32 v155, v155
    v_exp_f32 v156, v156
    v_exp_f32 v157, v157
    v_exp_f32 v158, v158
    v_exp_f32 v159, v159
    v_cvt_pk_bf16_f32 v244, v152, v153
    v_cvt_pk_bf16_f32 v245, v154, v155
    v_cvt_pk_bf16_f32 v246, v156, v157
    v_cvt_pk_bf16_f32 v247, v158, v159
    buffer_load_dwordx4 v14, s[12:15], s84 offen offset:2048 lds
    s_waitcnt lgkmcnt(2)
    v_mfma_f32_32x32x16_bf16 v[224:239], v[140:143], v[244:247], v[224:239]
    s_cmp_eq_u32 s59, 4
    s_cbranch_scc1 L_pat23
L_patb23:
    v_mfma_f32_32x32x16_bf16 v[144:159], v[48:51], v[96:99], v[176:191]
    ds_read_b64_tr_b16 v[136:137], v11 offset:6144
    ds_read_b64_tr_b16 v[138:139], v11 offset:6400
    ds_read_b64_tr_b16 v[140:141], v11 offset:6656
    ds_read_b64_tr_b16 v[142:143], v11 offset:6912
    buffer_load_dword v20, v19, s[28:31], s90 offen sc1
    v_exp_f32 v160, v160
    v_exp_f32 v161, v161
    v_exp_f32 v162, v162
    v_exp_f32 v163, v163
    v_mfma_f32_32x32x16_bf16 v[144:159], v[52:55], v[100:103], v[144:159]
    buffer_load_dwordx4 v15, s[12:15], s84 offen offset:3072 lds
    v_exp_f32 v164, v164
    v_exp_f32 v165, v165
    v_exp_f32 v166, v166
    v_exp_f32 v167, v167
    v_exp_f32 v168, v168
    v_cvt_pk_bf16_f32 v240, v160, v161
    v_cvt_pk_bf16_f32 v241, v162, v163
    v_cvt_pk_bf16_f32 v242, v164, v165
    v_cvt_pk_bf16_f32 v243, v166, v167
    v_exp_f32 v169, v169
    v_exp_f32 v170, v170
    s_waitcnt lgkmcnt(2)
    v_mfma_f32_32x32x16_bf16 v[224:239], v[136:139], v[240:243], v[224:239]
    ds_read_b128 v[40:43], v6 offset:12288
    ds_read_b128 v[44:47], v6 offset:13312
    s_add_u32 m0, s82, 4096
    s_add_u32 s84, s84, 25088
    buffer_load_dwordx4 v12, s[12:15], s84 offen lds
    v_exp_f32 v171, v171
    v_exp_f32 v172, v172
    v_exp_f32 v173, v173
    v_exp_f32 v174, v174
    v_exp_f32 v175, v175
    v_cvt_pk_bf16_f32 v244, v168, v169
    v_cvt_pk_bf16_f32 v245, v170, v171
    v_cvt_pk_bf16_f32 v246, v172, v173
    v_cvt_pk_bf16_f32 v247, v174, v175
    buffer_load_dwordx4 v13, s[12:15], s84 offen offset:1024 lds
    s_waitcnt lgkmcnt(2)
    v_mfma_f32_32x32x16_bf16 v[224:239], v[140:143], v[244:247], v[224:239]
    s_cmp_eq_u32 s59, 5
    s_cbranch_scc1 L_pat24
L_patb24:
    v_mfma_f32_32x32x16_bf16 v[160:175], v[56:59], v[96:99], v[176:191]
    ds_read_b64_tr_b16 v[136:137], v11 offset:8192
    ds_read_b64_tr_b16 v[138:139], v11 offset:8448
    ds_read_b64_tr_b16 v[140:141], v11 offset:8704
    ds_read_b64_tr_b16 v[142:143], v11 offset:8960
    buffer_load_dwordx4 v14, s[12:15], s84 offen offset:2048 lds
    v_exp_f32 v144, v144
    v_exp_f32 v145, v145
    v_exp_f32 v146, v146
    v_exp_f32 v147, v147
    v_mfma_f32_32x32x16_bf16 v[160:175], v[60:63], v[100:103], v[160:175]
    buffer_load_dwordx4 v15, s[12:15], s84 offen offset:3072 lds
    v_exp_f32 v148, v148
    v_exp_f32 v149, v149
    v_exp_f32 v150, v150
    v_exp_f32 v151, v151
    v_exp_f32 v152, v152
    v_cvt_pk_bf16_f32 v240, v144, v145
    v_cvt_pk_bf16_f32 v241, v146, v147
    v_cvt_pk_bf16_f32 v242, v148, v149
    v_cvt_pk_bf16_f32 v243, v150, v151
    v_exp_f32 v153, v153
    v_exp_f32 v154, v154
    s_waitcnt lgkmcnt(2)
    v_mfma_f32_32x32x16_bf16 v[224:239], v[136:139], v[240:243], v[224:239]
    ds_read_b128 v[48:51], v6 offset:14336
    ds_read_b128 v[52:55], v6 offset:15360
    s_add_u32 m0, s82, 8192
    s_add_u32 s84, s84, 25088
    buffer_load_dwordx4 v12, s[12:15], s84 offen lds
    v_exp_f32 v155, v155
    v_exp_f32 v156, v156
    v_exp_f32 v157, v157
    v_exp_f32 v158, v158
    v_exp_f32 v159, v159
    v_cvt_pk_bf16_f32 v244, v152, v153
    v_cvt_pk_bf16_f32 v245, v154, v155
    v_cvt_pk_bf16_f32 v246, v156, v157
    v_cvt_pk_bf16_f32 v247, v158, v159
    buffer_load_dwordx4 v13, s[12:15], s84 offen offset:1024 lds
    s_waitcnt lgkmcnt(2)
    v_mfma_f32_32x32x16_bf16 v[224:239], v[140:143], v[244:247], v[224:239]
    s_cmp_eq_u32 s59, 6
    s_cbranch_scc1 L_pat25
L_patb25:
    v_mfma_f32_32x32x16_bf16 v[144:159], v[40:43], v[96:99], v[176:191]
    ds_read_b64_tr_b16 v[136:137], v11 offset:10240
    ds_read_b64_tr_b16 v[138:139], v11 offset:10496
    ds_read_b64_tr_b16 v[140:141], v11 offset:10752
    ds_read_b64_tr_b16 v[142:143], v11 offset:11008
    buffer_load_dwordx4 v14, s[12:15], s84 offen offset:2048 lds
    v_exp_f32 v160, v160
    v_exp_f32 v161, v161
    v_exp_f32 v162, v162
    v_exp_f32 v163, v163
    v_mfma_f32_32x32x16_bf16 v[144:159], v[44:47], v[100:103], v[144:159]
    buffer_load_dwordx4 v15, s[12:15], s84 offen offset:3072 lds
    v_exp_f32 v164, v164
    v_exp_f32 v165, v165
    v_exp_f32 v166, v166
    v_exp_f32 v167, v167
    v_exp_f32 v168, v168
    v_cvt_pk_bf16_f32 v240, v160, v161
    v_cvt_pk_bf16_f32 v241, v162, v163
    v_cvt_pk_bf16_f32 v242, v164, v165
    v_cvt_pk_bf16_f32 v243, v166, v167
    v_exp_f32 v169, v169
    v_exp_f32 v170, v170
    s_waitcnt lgkmcnt(2)
    v_mfma_f32_32x32x16_bf16 v[224:239], v[136:139], v[240:243], v[224:239]
    ds_read_b128 v[56:59], v6 offset:16384
    ds_read_b128 v[60:63], v6 offset:17408
    v_exp_f32 v171, v171
    v_exp_f32 v172, v172
    v_exp_f32 v173, v173
    v_exp_f32 v174, v174
    v_exp_f32 v175, v175
    v_cvt_pk_bf16_f32 v244, v168, v169
    v_cvt_pk_bf16_f32 v245, v170, v171
    v_cvt_pk_bf16_f32 v246, v172, v173
    v_cvt_pk_bf16_f32 v247, v174, v175
    s_waitcnt lgkmcnt(2)
    s_nop 0
    v_mfma_f32_32x32x16_bf16 v[224:239], v[140:143], v[244:247], v[224:239]
    s_waitcnt vmcnt(9)
    v_cmp_ne_u32 vcc, v2, v20
    s_nop 0
    s_cbranch_vccnz L_slow26
L_back26:
    s_cmp_eq_u32 s59, 7
    s_cbranch_scc1 L_pat27
L_patb27:
    v_mfma_f32_32x32x16_bf16 v[160:175], v[48:51], v[96:99], v[176:191]
    ds_read_b64_tr_b16 v[136:137], v11 offset:12288
    ds_read_b64_tr_b16 v[138:139], v11 offset:12544
    ds_read_b64_tr_b16 v[140:141], v11 offset:12800
    ds_read_b64_tr_b16 v[142:143], v11 offset:13056
    buffer_load_dword v22, v21, s[28:31], s92 offen sc1
    v_exp_f32 v144, v144
    v_exp_f32 v145, v145
    v_exp_f32 v146, v146
    v_exp_f32 v147, v147
    v_mfma_f32_32x32x16_bf16 v[160:175], v[52:55], v[100:103], v[160:175]
    buffer_load_dwordx4 v[64:67], v1, s[28:31], s85 offen offset:0 sc1
    v_exp_f32 v148, v148
    v_exp_f32 v149, v149
    v_exp_f32 v150, v150
    v_exp_f32 v151, v151
    v_exp_f32 v152, v152
    v_cvt_pk_bf16_f32 v240, v144, v145
    v_cvt_pk_bf16_f32 v241, v146, v147
    v_cvt_pk_bf16_f32 v242, v148, v149
    v_cvt_pk_bf16_f32 v243, v150, v151
    v_exp_f32 v153, v153
    v_exp_f32 v154, v154
    s_waitcnt lgkmcnt(2)
    v_mfma_f32_32x32x16_bf16 v[224:239], v[136:139], v[240:243], v[224:239]
    buffer_load_dwordx4 v[68:71], v8, s[28:31], s85 offen offset:0 sc1
    v_exp_f32 v155, v155
    v_exp_f32 v156, v156
    v_exp_f32 v157, v157
    v_exp_f32 v158, v158
    v_exp_f32 v159, v159
    v_cvt_pk_bf16_f32 v244, v152, v153
    v_cvt_pk_bf16_f32 v245, v154, v155
    v_cvt_pk_bf16_f32 v246, v156, v157
    v_cvt_pk_bf16_f32 v247, v158, v159
    buffer_load_dwordx4 v[72:75], v1, s[28:31], s85 offen offset:1024 sc1
    s_waitcnt lgkmcnt(0)
    v_mfma_f32_32x32x16_bf16 v[224:239], v[140:143], v[244:247], v[224:239]
    v_mfma_f32_32x32x16_bf16 v[144:159], v[56:59], v[96:99], v[208:223]
    ds_read_b64_tr_b16 v[136:137], v11 offset:14336
    ds_read_b64_tr_b16 v[138:139], v11 offset:14592
    ds_read_b64_tr_b16 v[140:141], v11 offset:14848
    ds_read_b64_tr_b16 v[142:143], v11 offset:15104
    buffer_load_dwordx4 v[76:79], v8, s[28:31], s85 offen offset:1024 sc1
    v_exp_f32 v160, v160
    v_exp_f32 v161, v161
    v_exp_f32 v162, v162
    v_exp_f32 v163, v163
    v_mfma_f32_32x32x16_bf16 v[144:159], v[60:63], v[100:103], v[144:159]
    s_add_u32 s85, s85, 2048
    buffer_load_dwordx4 v[80:83], v1, s[28:31], s85 offen offset:0 sc1
    v_exp_f32 v164, v164
    v_exp_f32 v165, v165
    v_exp_f32 v166, v166
    v_exp_f32 v167, v167
    v_exp_f32 v168, v168
    v_cvt_pk_bf16_f32 v240, v160, v161
    v_cvt_pk_bf16_f32 v241, v162, v163
    v_cvt_pk_bf16_f32 v242, v164, v165
    v_cvt_pk_bf16_f32 v243, v166, v167
    v_exp_f32 v169, v169
    v_exp_f32 v170, v170
    s_waitcnt lgkmcnt(2)
    v_mfma_f32_32x32x16_bf16 v[224:239], v[136:139], v[240:243], v[224:239]
    buffer_load_dwordx4 v[84:87], v8, s[28:31], s85 offen offset:0 sc1
    v_exp_f32 v171, v171
    v_exp_f32 v172, v172
    v_exp_f32 v173, v173
    v_exp_f32 v174, v174
    v_exp_f32 v175, v175
    v_cvt_pk_bf16_f32 v244, v168, v169
    v_cvt_pk_bf16_f32 v245, v170, v171
    v_cvt_pk_bf16_f32 v246, v172, v173
    v_cvt_pk_bf16_f32 v247, v174, v175
    buffer_load_dwordx4 v[88:91], v1, s[28:31], s85 offen offset:1024 sc1
    s_waitcnt lgkmcnt(0)
    v_mfma_f32_32x32x16_bf16 v[224:239], v[140:143], v[244:247], v[224:239]
    ds_read_b64_tr_b16 v[136:137], v11 offset:16384
    ds_read_b64_tr_b16 v[138:139], v11 offset:16640
    ds_read_b64_tr_b16 v[140:141], v11 offset:16896
    ds_read_b64_tr_b16 v[142:143], v11 offset:17152
    buffer_load_dwordx4 v[92:95], v8, s[28:31], s85 offen offset:1024 sc1
    v_exp_f32 v144, v144
    v_exp_f32 v145, v145
    v_exp_f32 v146, v146
    v_exp_f32 v147, v147
    s_add_u32 s85, s85, 2048
    buffer_load_dwordx4 v[104:107], v1, s[28:31], s85 offen offset:0 sc1
    v_exp_f32 v148, v148
    v_exp_f32 v149, v149
    v_exp_f32 v150, v150
    v_exp_f32 v151, v151
    v_exp_f32 v152, v152
    v_cvt_pk_bf16_f32 v240, v144, v145
    v_cvt_pk_bf16_f32 v241, v146, v147
    v_cvt_pk_bf16_f32 v242, v148, v149
    v_cvt_pk_bf16_f32 v243, v150, v151
    v_exp_f32 v153, v153
    v_exp_f32 v154, v154
    s_waitcnt lgkmcnt(2)
    v_mfma_f32_32x32x16_bf16 v[224:239], v[136:139], v[240:243], v[224:239]
    buffer_load_dwordx4 v[108:111], v8, s[28:31], s85 offen offset:0 sc1
    v_exp_f32 v155, v155
    v_exp_f32 v156, v156
    v_exp_f32 v157, v157
    v_exp_f32 v158, v158
    v_exp_f32 v159, v159
    v_cvt_pk_bf16_f32 v244, v152, v153
    v_cvt_pk_bf16_f32 v245, v154, v155
    v_cvt_pk_bf16_f32 v246, v156, v157
    v_cvt_pk_bf16_f32 v247, v158, v159
    buffer_load_dwordx4 v[112:115], v1, s[28:31], s85 offen offset:1024 sc1
    s_waitcnt lgkmcnt(0)
    v_mfma_f32_32x32x16_bf16 v[224:239], v[140:143], v[244:247], v[224:239]
    v_lshrrev_b32 v18, 1, v21
    buffer_load_dwordx4 v[116:119], v8, s[28:31], s85 offen offset:1024 sc1
    s_nop 9
    v_mov_b32 v248, v236
    v_mov_b32 v249, v236
    s_nop 1
    v_permlane32_swap_b32 v248, v249
    ds_read_u16 v208, v18 offset:0
    s_add_u32 s85, s85, 2048
    buffer_load_dwordx4 v[120:123], v1, s[28:31], s85 offen offset:0 sc1
    ds_read_u16 v212, v18 offset:64
    s_cmp_eq_u32 s48, 0
    s_cselect_b32 s60, 0x3f80, 0
    v_mov_b32 v18, s60
    v_mov_b32 v209, 0
    v_mov_b32 v210, 0
    v_mov_b32 v211, 0
    v_mov_b32 v213, 0
    v_mov_b32 v214, 0
    v_mov_b32 v215, 0
    v_mov_b32 v217, 0
    buffer_load_dwordx4 v[124:127], v8, s[28:31], s85 offen offset:0 sc1
    v_mov_b32 v218, 0
    v_mov_b32 v219, 0
    v_cndmask_b32 v216, v18, 0, s[64:65]
    v_rcp_f32 v248, v249
    s_waitcnt vmcnt(14)
    v_mul_f32 v248, v248, v22
    v_pk_mul_f32 v[224:225], v[224:225], v[248:249] op_sel_hi:[1,0]
    v_pk_mul_f32 v[226:227], v[226:227], v[248:249] op_sel_hi:[1,0]
    v_pk_mul_f32 v[228:229], v[228:229], v[248:249] op_sel_hi:[1,0]
    v_pk_mul_f32 v[230:231], v[230:231], v[248:249] op_sel_hi:[1,0]
    buffer_load_dwordx4 v[128:131], v1, s[28:31], s85 offen offset:1024 sc1
    v_pk_mul_f32 v[232:233], v[232:233], v[248:249] op_sel_hi:[1,0]
    v_pk_mul_f32 v[234:235], v[234:235], v[248:249] op_sel_hi:[1,0]
    v_pk_mul_f32 v[236:237], v[236:237], v[248:249] op_sel_hi:[1,0]
    v_pk_mul_f32 v[238:239], v[238:239], v[248:249] op_sel_hi:[1,0]
    v_cvt_pk_bf16_f32 v240, v224, v225
    v_cvt_pk_bf16_f32 v241, v226, v227
    v_cvt_pk_bf16_f32 v242, v228, v229
    v_cvt_pk_bf16_f32 v243, v230, v231
    v_cvt_pk_bf16_f32 v244, v232, v233
    v_cvt_pk_bf16_f32 v245, v234, v235
    v_cvt_pk_bf16_f32 v246, v236, v237
    v_cvt_pk_bf16_f32 v247, v238, v239
    v_cndmask_b32 v246, v246, 0, s[64:65]
    buffer_store_dwordx4 v[240:243], v1, s[28:31], s39 offen sc1
    buffer_store_dwordx4 v[244:247], v1, s[28:31], s39 offen offset:1024 sc1
    s_cmp_ge_u32 s56, 28
    s_cbranch_scc1 L_idle
    s_waitcnt vmcnt(15)
    v_mfma_f32_32x32x16_bf16 v[144:159], a[0:3], v[64:67], 0
    ds_read_b64_tr_b16 a[192:193], v16 offset:49152
    ds_read_b64_tr_b16 a[194:195], v16 offset:50176
    v_mfma_f32_32x32x16_bf16 v[160:175], a[4:7], v[64:67], 0
    ds_read_b64_tr_b16 a[196:197], v17 offset:49152
    ds_read_b64_tr_b16 a[198:199], v17 offset:50176
    v_mfma_f32_32x32x16_bf16 v[176:191], a[0:3], v[68:71], 0
    ds_read_b64_tr_b16 a[200:201], v16 offset:51200
    ds_read_b64_tr_b16 a[202:203], v16 offset:52224
    v_mfma_f32_32x32x16_bf16 v[192:207], a[4:7], v[68:71], 0
    ds_read_b64_tr_b16 a[204:205], v17 offset:51200
    ds_read_b64_tr_b16 a[206:207], v17 offset:52224
    s_waitcnt vmcnt(14)
    v_mfma_f32_32x32x16_bf16 v[144:159], a[8:11], v[72:75], v[144:159]
    buffer_load_dwordx4 v[132:135], v8, s[28:31], s85 offen offset:1024 sc1
    ds_read_b64_tr_b16 a[208:209], v16 offset:53248
    ds_read_b64_tr_b16 a[210:211], v16 offset:54272
    v_mfma_f32_32x32x16_bf16 v[160:175], a[12:15], v[72:75], v[160:175]
    ds_read_b64_tr_b16 a[212:213], v17 offset:53248
    ds_read_b64_tr_b16 a[214:215], v17 offset:54272
    s_waitcnt vmcnt(14)
    v_mfma_f32_32x32x16_bf16 v[176:191], a[8:11], v[76:79], v[176:191]
    ds_read_b64_tr_b16 a[216:217], v16 offset:55296
    ds_read_b64_tr_b16 a[218:219], v16 offset:56320
    v_mfma_f32_32x32x16_bf16 v[192:207], a[12:15], v[76:79], v[192:207]
    ds_read_b64_tr_b16 a[220:221], v17 offset:55296
    ds_read_b64_tr_b16 a[222:223], v17 offset:56320
    s_waitcnt vmcnt(12)
    v_mfma_f32_32x32x16_bf16 v[144:159], a[16:19], v[80:83], v[144:159]
    s_add_u32 s85, s85, 2048
    buffer_load_dwordx4 v[24:27], v1, s[28:31], s85 offen offset:0 sc1
    ds_read_b64_tr_b16 a[224:225], v16 offset:57344
    ds_read_b64_tr_b16 a[226:227], v16 offset:58368
    v_mfma_f32_32x32x16_bf16 v[160:175], a[20:23], v[80:83], v[160:175]
    ds_read_b64_tr_b16 a[228:229], v17 offset:57344
    ds_read_b64_tr_b16 a[230:231], v17 offset:58368
    v_mfma_f32_32x32x16_bf16 v[176:191], a[16:19], v[84:87], v[176:191]
    buffer_load_dwordx4 v[28:31], v8, s[28:31], s85 offen offset:0 sc1
    ds_read_b64_tr_b16 a[232:233], v16 offset:59392
    ds_read_b64_tr_b16 a[234:235], v16 offset:60416
    v_mfma_f32_32x32x16_bf16 v[192:207], a[20:23], v[84:87], v[192:207]
    ds_read_b64_tr_b16 a[236:237], v17 offset:59392
    ds_read_b64_tr_b16 a[238:239], v17 offset:60416
    s_waitcnt vmcnt(13)
    v_mfma_f32_32x32x16_bf16 v[144:159], a[24:27], v[88:91], v[144:159]
    buffer_load_dwordx4 v[32:35], v1, s[28:31], s85 offen offset:1024 sc1
    ds_read_b64_tr_b16 a[240:241], v16 offset:0
    ds_read_b64_tr_b16 a[242:243], v16 offset:1024
    v_mfma_f32_32x32x16_bf16 v[160:175], a[28:31], v[88:91], v[160:175]
    ds_read_b64_tr_b16 a[244:245], v17 offset:0
    ds_read_b64_tr_b16 a[246:247], v17 offset:1024
    s_waitcnt vmcnt(13)
    v_mfma_f32_32x32x16_bf16 v[176:191], a[24:27], v[92:95], v[176:191]
    buffer_load_dwordx4 v[36:39], v8, s[28:31], s85 offen offset:1024 sc1
    ds_read_b64_tr_b16 a[248:249], v16 offset:2048
    ds_read_b64_tr_b16 a[250:251], v16 offset:3072
    v_mfma_f32_32x32x16_bf16 v[192:207], a[28:31], v[92:95], v[192:207]
    ds_read_b64_tr_b16 a[252:253], v17 offset:2048
    ds_read_b64_tr_b16 a[254:255], v17 offset:3072
    s_waitcnt vmcnt(12)
    v_mfma_f32_32x32x16_bf16 v[144:159], a[32:35], v[104:107], v[144:159]
    buffer_load_dword v9, v21, s[28:31], s93 offen offset:0 sc1
    ds_read_b64_tr_b16 a[0:1], v16 offset:4096
    ds_read_b64_tr_b16 a[2:3], v16 offset:5120
    v_mfma_f32_32x32x16_bf16 v[160:175], a[36:39], v[104:107], v[160:175]
    ds_read_b64_tr_b16 a[4:5], v17 offset:4096
    ds_read_b64_tr_b16 a[6:7], v17 offset:5120
    v_mfma_f32_32x32x16_bf16 v[176:191], a[32:35], v[108:111], v[176:191]
    buffer_load_dword v10, v21, s[28:31], s93 offen offset:128 sc1
    ds_read_b64_tr_b16 a[8:9], v16 offset:6144
    ds_read_b64_tr_b16 a[10:11], v16 offset:7168
    v_mfma_f32_32x32x16_bf16 v[192:207], a[36:39], v[108:111], v[192:207]
    s_add_u32 s85, s85, 2048
    buffer_load_dwordx4 v[64:67], v1, s[28:31], s85 offen offset:0 sc1
    ds_read_b64_tr_b16 a[12:13], v17 offset:6144
    ds_read_b64_tr_b16 a[14:15], v17 offset:7168
    s_waitcnt vmcnt(14)
    v_mfma_f32_32x32x16_bf16 v[144:159], a[40:43], v[112:115], v[144:159]
    buffer_load_dwordx4 v[68:71], v8, s[28:31], s85 offen offset:0 sc1
    ds_read_b64_tr_b16 a[16:17], v16 offset:8192
    ds_read_b64_tr_b16 a[18:19], v16 offset:9216
    v_mfma_f32_32x32x16_bf16 v[160:175], a[44:47], v[112:115], v[160:175]
    ds_read_b64_tr_b16 a[20:21], v17 offset:8192
    ds_read_b64_tr_b16 a[22:23], v17 offset:9216
    s_waitcnt vmcnt(14)
    v_mfma_f32_32x32x16_bf16 v[176:191], a[40:43], v[116:119], v[176:191]
    buffer_load_dwordx4 v[72:75], v1, s[28:31], s85 offen offset:1024 sc1
    ds_read_b64_tr_b16 a[24:25], v16 offset:10240
    ds_read_b64_tr_b16 a[26:27], v16 offset:11264
    v_mfma_f32_32x32x16_bf16 v[192:207], a[44:47], v[116:119], v[192:207]
    ds_read_b64_tr_b16 a[28:29], v17 offset:10240
    ds_read_b64_tr_b16 a[30:31], v17 offset:11264
    s_waitcnt vmcnt(13) lgkmcnt(15)
    v_mfma_f32_32x32x16_bf16 v[144:159], v[208:211], v[216:219], v[144:159]
    s_waitcnt vmcnt(10)
    buffer_store_dword v2, v3, s[28:31], s24 offen sc1
    v_mfma_f32_32x32x16_bf16 v[160:175], v[212:215], v[216:219], v[160:175]
    v_mfma_f32_32x32x16_bf16 v[176:191], v[208:211], v[216:219], v[176:191]
    buffer_load_dwordx4 v[76:79], v8, s[28:31], s85 offen offset:1024 sc1
    v_mfma_f32_32x32x16_bf16 v[192:207], v[212:215], v[216:219], v[192:207]
    s_add_u32 s85, s85, 2048
    buffer_load_dwordx4 v[80:83], v1, s[28:31], s85 offen offset:0 sc1
    v_mfma_f32_32x32x16_bf16 v[144:159], a[48:51], v[120:123], v[144:159]
    v_mfma_f32_32x32x16_bf16 v[160:175], a[52:55], v[120:123], v[160:175]
    buffer_load_dwordx4 v[84:87], v8, s[28:31], s85 offen offset:0 sc1
    v_mfma_f32_32x32x16_bf16 v[176:191], a[48:51], v[124:127], v[176:191]
    v_mfma_f32_32x32x16_bf16 v[192:207], a[52:55], v[124:127], v[192:207]
    buffer_load_dwordx4 v[88:91], v1, s[28:31], s85 offen offset:1024 sc1
    v_mfma_f32_32x32x16_bf16 v[144:159], a[56:59], v[128:131], v[144:159]
    v_mfma_f32_32x32x16_bf16 v[160:175], a[60:63], v[128:131], v[160:175]
    buffer_load_dwordx4 v[92:95], v8, s[28:31], s85 offen offset:1024 sc1
    s_waitcnt vmcnt(15)
    v_mfma_f32_32x32x16_bf16 v[176:191], a[56:59], v[132:135], v[176:191]
    v_mfma_f32_32x32x16_bf16 v[192:207], a[60:63], v[132:135], v[192:207]
    s_add_u32 s85, s85, 2048
    buffer_load_dwordx4 v[104:107], v1, s[28:31], s85 offen offset:0 sc1
    s_waitcnt vmcnt(14)
    v_mfma_f32_32x32x16_bf16 v[144:159], a[64:67], v[24:27], v[144:159]
    v_mfma_f32_32x32x16_bf16 v[160:175], a[68:71], v[24:27], v[160:175]
    buffer_load_dwordx4 v[108:111], v8, s[28:31], s85 offen offset:0 sc1
    v_mfma_f32_32x32x16_bf16 v[176:191], a[64:67], v[28:31], v[176:191]
    v_mfma_f32_32x32x16_bf16 v[192:207], a[68:71], v[28:31], v[192:207]
    buffer_load_dwordx4 v[112:115], v1, s[28:31], s85 offen offset:1024 sc1
    s_waitcnt vmcnt(15)
    v_mfma_f32_32x32x16_bf16 v[144:159], a[72:75], v[32:35], v[144:159]
    v_mfma_f32_32x32x16_bf16 v[160:175], a[76:79], v[32:35], v[160:175]
    buffer_load_dwordx4 v[116:119], v8, s[28:31], s85 offen offset:1024 sc1
    s_waitcnt vmcnt(15)
    v_mfma_f32_32x32x16_bf16 v[176:191], a[72:75], v[36:39], v[176:191]
    v_mfma_f32_32x32x16_bf16 v[192:207], a[76:79], v[36:39], v[192:207]
    s_waitcnt vmcnt(11)
    v_mfma_f32_32x32x16_bf16 v[144:159], a[80:83], v[64:67], v[144:159]
    v_mfma_f32_32x32x16_bf16 v[160:175], a[84:87], v[64:67], v[160:175]
    v_mfma_f32_32x32x16_bf16 v[176:191], a[80:83], v[68:71], v[176:191]
    s_add_u32 s85, s85, 2048
    buffer_load_dwordx4 v[120:123], v1, s[28:31], s85 offen offset:0 sc1
    v_mfma_f32_32x32x16_bf16 v[192:207], a[84:87], v[68:71], v[192:207]
    s_waitcnt vmcnt(11)
    v_mfma_f32_32x32x16_bf16 v[144:159], a[88:91], v[72:75], v[144:159]
    buffer_load_dwordx4 v[124:127], v8, s[28:31], s85 offen offset:0 sc1
    v_mfma_f32_32x32x16_bf16 v[160:175], a[92:95], v[72:75], v[160:175]
    s_waitcnt vmcnt(10)
    v_mfma_f32_32x32x16_bf16 v[176:191], a[88:91], v[76:79], v[176:191]
    buffer_load_dwordx4 v[128:131], v1, s[28:31], s85 offen offset:1024 sc1
    v_mfma_f32_32x32x16_bf16 v[192:207], a[92:95], v[76:79], v[192:207]
    s_waitcnt vmcnt(9)
    v_mfma_f32_32x32x16_bf16 v[144:159], a[96:99], v[80:83], v[144:159]
    buffer_load_dwordx4 v[132:135], v8, s[28:31], s85 offen offset:1024 sc1
    v_mfma_f32_32x32x16_bf16 v[160:175], a[100:103], v[80:83], v[160:175]
    v_mfma_f32_32x32x16_bf16 v[176:191], a[96:99], v[84:87], v[176:191]
    s_add_u32 s85, s85, 2048
    buffer_load_dwordx4 v[24:27], v1, s[28:31], s85 offen offset:0 sc1
    v_mfma_f32_32x32x16_bf16 v[192:207], a[100:103], v[84:87], v[192:207]
    s_waitcnt vmcnt(10)
    v_mfma_f32_32x32x16_bf16 v[144:159], a[104:107], v[88:91], v[144:159]
    buffer_load_dwordx4 v[28:31], v8, s[28:31], s85 offen offset:0 sc1
    v_mfma_f32_32x32x16_bf16 v[160:175], a[108:111], v[88:91], v[160:175]
    s_waitcnt vmcnt(10)
    v_mfma_f32_32x32x16_bf16 v[176:191], a[104:107], v[92:95], v[176:191]
    buffer_load_dwordx4 v[32:35], v1, s[28:31], s85 offen offset:1024 sc1
    v_mfma_f32_32x32x16_bf16 v[192:207], a[108:111], v[92:95], v[192:207]
    s_waitcnt vmcnt(9)
    s_add_u32 s90, s90, 131072
    v_mfma_f32_32x32x16_bf16 v[144:159], a[112:115], v[104:107], v[144:159]
    buffer_load_dword v20, v19, s[28:31], s90 offen sc1
    v_mfma_f32_32x32x16_bf16 v[160:175], a[116:119], v[104:107], v[160:175]
    v_mfma_f32_32x32x16_bf16 v[176:191], a[112:115], v[108:111], v[176:191]
    buffer_load_dwordx4 v[36:39], v8, s[28:31], s85 offen offset:1024 sc1
    v_mfma_f32_32x32x16_bf16 v[192:207], a[116:119], v[108:111], v[192:207]
    s_add_u32 s85, s85, 2048
    buffer_load_dwordx4 v[64:67], v1, s[28:31], s85 offen offset:0 sc1
    s_waitcnt vmcnt(11)
    v_mfma_f32_32x32x16_bf16 v[144:159], a[120:123], v[112:115], v[144:159]
    v_mfma_f32_32x32x16_bf16 v[160:175], a[124:127], v[112:115], v[160:175]
    buffer_load_dwordx4 v[68:71], v8, s[28:31], s85 offen offset:0 sc1
    s_waitcnt vmcnt(11)
    v_mfma_f32_32x32x16_bf16 v[176:191], a[120:123], v[116:119], v[176:191]
    v_mfma_f32_32x32x16_bf16 v[192:207], a[124:127], v[116:119], v[192:207]
    buffer_load_dwordx4 v[72:75], v1, s[28:31], s85 offen offset:1024 sc1
    s_waitcnt vmcnt(10)
    v_mfma_f32_32x32x16_bf16 v[144:159], a[128:131], v[120:123], v[144:159]
    v_mfma_f32_32x32x16_bf16 v[160:175], a[132:135], v[120:123], v[160:175]
    buffer_load_dwordx4 v[76:79], v8, s[28:31], s85 offen offset:1024 sc1
    v_mfma_f32_32x32x16_bf16 v[176:191], a[128:131], v[124:127], v[176:191]
    v_mfma_f32_32x32x16_bf16 v[192:207], a[132:135], v[124:127], v[192:207]
    s_add_u32 s85, s85, 2048
    buffer_load_dwordx4 v[80:83], v1, s[28:31], s85 offen offset:0 sc1
    s_waitcnt vmcnt(11)
    v_mfma_f32_32x32x16_bf16 v[144:159], a[136:139], v[128:131], v[144:159]
    v_mfma_f32_32x32x16_bf16 v[160:175], a[140:143], v[128:131], v[160:175]
    buffer_load_dwordx4 v[84:87], v8, s[28:31], s85 offen offset:0 sc1
    s_waitcnt vmcnt(11)
    v_mfma_f32_32x32x16_bf16 v[176:191], a[136:139], v[132:135], v[176:191]
    v_mfma_f32_32x32x16_bf16 v[192:207], a[140:143], v[132:135], v[192:207]
    buffer_load_dwordx4 v[88:91], v1, s[28:31], s85 offen offset:1024 sc1
    s_waitcnt vmcnt(10)
    v_mfma_f32_32x32x16_bf16 v[144:159], a[144:147], v[24:27], v[144:159]
    v_mfma_f32_32x32x16_bf16 v[160:175], a[148:151], v[24:27], v[160:175]
    buffer_load_dwordx4 v[92:95], v8, s[28:31], s85 offen offset:1024 sc1
    v_mfma_f32_32x32x16_bf16 v[176:191], a[144:147], v[28:31], v[176:191]
    v_mfma_f32_32x32x16_bf16 v[192:207], a[148:151], v[28:31], v[192:207]
    s_add_u32 s85, s85, 2048
    buffer_load_dwordx4 v[104:107], v1, s[28:31], s85 offen offset:0 sc1
    s_waitcnt vmcnt(11)
    v_mfma_f32_32x32x16_bf16 v[144:159], a[152:155], v[32:35], v[144:159]
    v_mfma_f32_32x32x16_bf16 v[160:175], a[156:159], v[32:35], v[160:175]
    buffer_load_dwordx4 v[108:111], v8, s[28:31], s85 offen offset:0 sc1
    s_waitcnt vmcnt(10)
    v_mfma_f32_32x32x16_bf16 v[176:191], a[152:155], v[36:39], v[176:191]
    v_mfma_f32_32x32x16_bf16 v[192:207], a[156:159], v[36:39], v[192:207]
    buffer_load_dwordx4 v[112:115], v1, s[28:31], s85 offen offset:1024 sc1
    v_cmp_ne_u32 vcc, v2, v20
    s_nop 0
    s_cbranch_vccnz L_slow28
L_back28:
    s_waitcnt vmcnt(9)
    v_mfma_f32_32x32x16_bf16 v[144:159], a[160:163], v[64:67], v[144:159]
    v_mfma_f32_32x32x16_bf16 v[160:175], a[164:167], v[64:67], v[160:175]
    buffer_load_dwordx4 v[116:119], v8, s[28:31], s85 offen offset:1024 sc1
    v_mfma_f32_32x32x16_bf16 v[176:191], a[160:163], v[68:71], v[176:191]
    v_mfma_f32_32x32x16_bf16 v[192:207], a[164:167], v[68:71], v[192:207]
    s_add_u32 s85, s85, 2048
    buffer_load_dwordx4 v[120:123], v1, s[28:31], s85 offen offset:0 sc1
    s_waitcnt vmcnt(10)
    v_mfma_f32_32x32x16_bf16 v[144:159], a[168:171], v[72:75], v[144:159]
    v_mfma_f32_32x32x16_bf16 v[160:175], a[172:175], v[72:75], v[160:175]
    buffer_load_dwordx4 v[124:127], v8, s[28:31], s85 offen offset:0 sc1
    s_waitcnt vmcnt(10)
    v_mfma_f32_32x32x16_bf16 v[176:191], a[168:171], v[76:79], v[176:191]
    v_mfma_f32_32x32x16_bf16 v[192:207], a[172:175], v[76:79], v[192:207]
    buffer_load_dwordx4 v[128:131], v1, s[28:31], s85 offen offset:1024 sc1
    s_waitcnt vmcnt(9)
    v_mfma_f32_32x32x16_bf16 v[144:159], a[176:179], v[80:83], v[144:159]
    v_add_u32 v24, s82, v1
    s_xor_b32 s60, s48, 1
    s_mul_i32 s60, s60, 12288
    s_add_u32 s60, s60, 10240
    v_add_u32 v25, s60, v1
    s_xor_b32 s60, s48, 2
    v_mfma_f32_32x32x16_bf16 v[160:175], a[180:183], v[80:83], v[160:175]
    buffer_load_dwordx4 v[132:135], v8, s[28:31], s85 offen offset:1024 sc1
    s_mul_i32 s60, s60, 12288
    s_add_u32 s60, s60, 12288
    v_add_u32 v26, s60, v1
    s_xor_b32 s60, s48, 3
    v_mfma_f32_32x32x16_bf16 v[176:191], a[176:179], v[84:87], v[176:191]
    s_mul_i32 s60, s60, 12288
    s_add_u32 s60, s60, 14336
    v_add_u32 v27, s60, v1
    v_and_b32 v28, 31, v0
    v_mul_u32_u24 v28, 896, v28
    v_lshrrev_b32 v29, 5, v0
    v_mfma_f32_32x32x16_bf16 v[192:207], a[180:183], v[84:87], v[192:207]
    buffer_load_dwordx4 a[32:35], v1, s[28:31], s86 offen offset:0 sc1
    v_lshl_add_u32 v28, v29, 4, v28
    v_sub_f32 v9, 1.0, v9
    v_sub_f32 v10, 1.0, v10
    s_waitcnt vmcnt(10)
    v_mfma_f32_32x32x16_bf16 v[144:159], a[184:187], v[88:91], v[144:159]
    v_mfma_f32_32x32x16_bf16 v[160:175], a[188:191], v[88:91], v[160:175]
    buffer_load_dwordx4 a[36:39], v1, s[28:31], s86 offen offset:1024 sc1
    s_waitcnt vmcnt(10)
    v_mfma_f32_32x32x16_bf16 v[176:191], a[184:187], v[92:95], v[176:191]
    v_mfma_f32_32x32x16_bf16 v[192:207], a[188:191], v[92:95], v[192:207]
    buffer_load_dwordx4 a[40:43], v1, s[28:31], s86 offen offset:2048 sc1
    s_waitcnt vmcnt(9)
    v_mfma_f32_32x32x16_bf16 v[144:159], a[192:195], v[104:107], v[144:159]
    v_mfma_f32_32x32x16_bf16 v[160:175], a[196:199], v[104:107], v[160:175]
    buffer_load_dwordx4 a[44:47], v1, s[28:31], s86 offen offset:3072 sc1
    v_mfma_f32_32x32x16_bf16 v[176:191], a[192:195], v[108:111], v[176:191]
    v_mfma_f32_32x32x16_bf16 v[192:207], a[196:199], v[108:111], v[192:207]
    s_add_u32 s86, s86, 4096
    buffer_load_dwordx4 a[48:51], v1, s[28:31], s86 offen offset:0 sc1
    s_waitcnt vmcnt(10)
    v_mfma_f32_32x32x16_bf16 v[144:159], a[200:203], v[112:115], v[144:159]
    v_mfma_f32_32x32x16_bf16 v[160:175], a[204:207], v[112:115], v[160:175]
    buffer_load_dwordx4 a[52:55], v1, s[28:31], s86 offen offset:1024 sc1
    s_waitcnt vmcnt(10)
    v_mfma_f32_32x32x16_bf16 v[176:191], a[200:203], v[116:119], v[176:191]
    v_mfma_f32_32x32x16_bf16 v[192:207], a[204:207], v[116:119], v[192:207]
    buffer_load_dwordx4 a[56:59], v1, s[28:31], s86 offen offset:2048 sc1
    s_waitcnt vmcnt(9)
    v_mfma_f32_32x32x16_bf16 v[144:159], a[208:211], v[120:123], v[144:159]
    s_waitcnt vmcnt(8)
    v_mfma_f32_32x32x16_bf16 v[144:159], a[216:219], v[128:131], v[144:159]
    buffer_load_dwordx4 a[60:63], v1, s[28:31], s86 offen offset:3072 sc1
    v_mfma_f32_32x32x16_bf16 v[160:175], a[212:215], v[120:123], v[160:175]
    v_mfma_f32_32x32x16_bf16 v[160:175], a[220:223], v[128:131], v[160:175]
    s_add_u32 s86, s86, 28672
    buffer_load_dwordx4 a[64:67], v1, s[28:31], s86 offen offset:0 sc1
    s_nop 6
    v_mul_f32 v144, v9, v144
    v_mul_f32 v145, v9, v145
    v_mul_f32 v146, v9, v146
    v_mul_f32 v147, v9, v147
    v_mul_f32 v148, v9, v148
    v_mfma_f32_32x32x16_bf16 v[176:191], a[208:211], v[124:127], v[176:191]
    v_mul_f32 v149, v9, v149
    v_mul_f32 v150, v9, v150
    v_mul_f32 v151, v9, v151
    v_mul_f32 v152, v9, v152
    v_mul_f32 v153, v9, v153
    v_mul_f32 v154, v9, v154
    v_mul_f32 v155, v9, v155
    v_mul_f32 v156, v9, v156
    s_waitcnt vmcnt(9)
    v_mfma_f32_32x32x16_bf16 v[176:191], a[216:219], v[132:135], v[176:191]
    buffer_load_dwordx4 a[68:71], v1, s[28:31], s86 offen offset:1024 sc1
    v_mul_f32 v157, v9, v157
    v_mul_f32 v158, v9, v158
    v_mul_f32 v159, v9, v159
    v_mul_f32 v160, v9, v160
    v_mul_f32 v161, v9, v161
    v_mul_f32 v162, v9, v162
    v_mfma_f32_32x32x16_bf16 v[192:207], a[212:215], v[124:127], v[192:207]
    buffer_load_dwordx4 a[72:75], v1, s[28:31], s86 offen offset:2048 sc1
    v_mul_f32 v163, v9, v163
    v_mul_f32 v164, v9, v164
    v_mul_f32 v165, v9, v165
    v_mul_f32 v166, v9, v166
    v_mul_f32 v167, v9, v167
    v_mul_f32 v168, v9, v168
    v_mfma_f32_32x32x16_bf16 v[192:207], a[220:223], v[132:135], v[192:207]
    v_mul_f32 v169, v9, v169
    v_mul_f32 v170, v9, v170
    v_mul_f32 v171, v9, v171
    v_mul_f32 v172, v9, v172
    v_mul_f32 v173, v9, v173
    v_mul_f32 v174, v9, v174
    v_mul_f32 v175, v9, v175
    s_waitcnt vmcnt(9)
    v_mfma_f32_32x32x16_bf16 v[144:159], a[224:227], a[32:35], v[144:159]
    buffer_load_dwordx4 a[76:79], v1, s[28:31], s86 offen offset:3072 sc1
    v_mul_f32 v176, v10, v176
    v_mul_f32 v177, v10, v177
    v_mul_f32 v178, v10, v178
    v_mul_f32 v179, v10, v179
    v_mfma_f32_32x32x16_bf16 v[160:175], a[228:231], a[32:35], v[160:175]
    v_mul_f32 v180, v10, v180
    v_mul_f32 v181, v10, v181
    v_mul_f32 v182, v10, v182
    v_mul_f32 v183, v10, v183
    v_mul_f32 v184, v10, v184
    v_mul_f32 v185, v10, v185
    v_mfma_f32_32x32x16_bf16 v[144:159], a[232:235], a[36:39], v[144:159]
    s_add_u32 s86, s86, 4096
    buffer_load_dwordx4 a[80:83], v1, s[28:31], s86 offen offset:0 sc1
    v_mul_f32 v186, v10, v186
    v_mul_f32 v187, v10, v187
    v_mul_f32 v188, v10, v188
    v_mfma_f32_32x32x16_bf16 v[160:175], a[236:239], a[36:39], v[160:175]
    v_mul_f32 v189, v10, v189
    v_mul_f32 v190, v10, v190
    v_mul_f32 v191, v10, v191
    v_mul_f32 v192, v10, v192
    v_mul_f32 v193, v10, v193
    v_mul_f32 v194, v10, v194
    s_waitcnt vmcnt(10)
    v_mfma_f32_32x32x16_bf16 v[144:159], a[240:243], a[40:43], v[144:159]
    buffer_load_dwordx4 a[84:87], v1, s[28:31], s86 offen offset:1024 sc1
    v_mul_f32 v195, v10, v195
    v_mul_f32 v196, v10, v196
    v_mul_f32 v197, v10, v197
    v_mul_f32 v198, v10, v198
    v_mfma_f32_32x32x16_bf16 v[160:175], a[244:247], a[40:43], v[160:175]
    v_mul_f32 v199, v10, v199
    v_mul_f32 v200, v10, v200
    v_mul_f32 v201, v10, v201
    v_mul_f32 v202, v10, v202
    v_mul_f32 v203, v10, v203
    v_mul_f32 v204, v10, v204
    s_waitcnt vmcnt(10)
    v_mfma_f32_32x32x16_bf16 v[144:159], a[248:251], a[44:47], v[144:159]
    buffer_load_dwordx4 a[88:91], v1, s[28:31], s86 offen offset:2048 sc1
    v_mul_f32 v205, v10, v205
    v_mul_f32 v206, v10, v206
    v_mul_f32 v207, v10, v207
    v_mfma_f32_32x32x16_bf16 v[160:175], a[252:255], a[44:47], v[160:175]
    s_waitcnt vmcnt(9) lgkmcnt(12)
    v_mfma_f32_32x32x16_bf16 v[160:175], a[4:7], a[48:51], v[160:175]
    buffer_load_dwordx4 a[92:95], v1, s[28:31], s86 offen offset:3072 sc1
    s_waitcnt lgkmcnt(8)
    v_mfma_f32_32x32x16_bf16 v[160:175], a[12:15], a[52:55], v[160:175]
    s_waitcnt vmcnt(9) lgkmcnt(4)
    v_mfma_f32_32x32x16_bf16 v[160:175], a[20:23], a[56:59], v[160:175]
    s_waitcnt vmcnt(8) lgkmcnt(0)
    v_mfma_f32_32x32x16_bf16 v[160:175], a[28:31], a[60:63], v[160:175]
    v_mfma_f32_32x32x16_bf16 v[144:159], a[0:3], a[48:51], v[144:159]
    v_mfma_f32_32x32x16_bf16 v[144:159], a[8:11], a[52:55], v[144:159]
    v_mfma_f32_32x32x16_bf16 v[144:159], a[16:19], a[56:59], v[144:159]
    s_nop 8
    ds_write_b128 v24, v[160:163] offset:2048
    v_mfma_f32_32x32x16_bf16 v[144:159], a[24:27], a[60:63], v[144:159]
    ds_write_b128 v24, v[164:167] offset:3072
    s_waitcnt vmcnt(6)
    v_mfma_f32_32x32x16_bf16 v[176:191], a[224:227], a[64:67], v[176:191]
    ds_write_b128 v24, v[168:171] offset:6144
    v_mfma_f32_32x32x16_bf16 v[192:207], a[228:231], a[64:67], v[192:207]
    ds_write_b128 v24, v[172:175] offset:7168
    v_mfma_f32_32x32x16_bf16 v[176:191], a[232:235], a[68:71], v[176:191]
    s_nop 4
    ds_write_b128 v24, v[152:155] offset:4096
    v_mfma_f32_32x32x16_bf16 v[192:207], a[236:239], a[68:71], v[192:207]
    ds_write_b128 v24, v[156:159] offset:5120
    s_waitcnt vmcnt(5)
    v_mfma_f32_32x32x16_bf16 v[176:191], a[240:243], a[72:75], v[176:191]
    v_mfma_f32_32x32x16_bf16 v[192:207], a[244:247], a[72:75], v[192:207]
    s_waitcnt lgkmcnt(0)
    s_barrier
    ds_read_b128 v[216:219], v25 offset:0
    ds_read_b128 v[220:223], v25 offset:1024
    s_waitcnt vmcnt(4)
    v_mfma_f32_32x32x16_bf16 v[176:191], a[248:251], a[76:79], v[176:191]
    ds_read_b128 v[224:227], v26 offset:0
    ds_read_b128 v[228:231], v26 offset:1024
    v_mfma_f32_32x32x16_bf16 v[192:207], a[252:255], a[76:79], v[192:207]
    ds_read_b128 v[232:235], v27 offset:0
    ds_read_b128 v[236:239], v27 offset:1024
    s_waitcnt lgkmcnt(5)
    v_add_f32 v144, v144, v216
    v_add_f32 v145, v145, v217
    v_add_f32 v146, v146, v218
    v_add_f32 v147, v147, v219
    s_waitcnt vmcnt(2)
    v_mfma_f32_32x32x16_bf16 v[192:207], a[4:7], a[80:83], v[192:207]
    s_waitcnt lgkmcnt(4)
    v_add_f32 v148, v148, v220
    v_add_f32 v149, v149, v221
    v_add_f32 v150, v150, v222
    v_add_f32 v151, v151, v223
    s_waitcnt lgkmcnt(3)
    v_add_f32 v144, v144, v224
    v_add_f32 v145, v145, v225
    v_mfma_f32_32x32x16_bf16 v[192:207], a[12:15], a[84:87], v[192:207]
    v_add_f32 v146, v146, v226
    v_add_f32 v147, v147, v227
    s_waitcnt lgkmcnt(2)
    v_add_f32 v148, v148, v228
    v_add_f32 v149, v149, v229
    v_add_f32 v150, v150, v230
    v_add_f32 v151, v151, v231
    s_waitcnt vmcnt(1)
    v_mfma_f32_32x32x16_bf16 v[192:207], a[20:23], a[88:91], v[192:207]
    s_waitcnt lgkmcnt(1)
    v_add_f32 v144, v144, v232
    v_add_f32 v145, v145, v233
    v_add_f32 v146, v146, v234
    v_add_f32 v147, v147, v235
    s_waitcnt lgkmcnt(0)
    v_add_f32 v148, v148, v236
    v_add_f32 v149, v149, v237
    s_waitcnt vmcnt(0)
    v_mfma_f32_32x32x16_bf16 v[192:207], a[28:31], a[92:95], v[192:207]
    v_add_f32 v150, v150, v238
    v_add_f32 v151, v151, v239
    v_cvt_pk_bf16_f32 v32, v144, v145
    v_cvt_pk_bf16_f32 v33, v146, v147
    v_cvt_pk_bf16_f32 v34, v148, v149
    v_cvt_pk_bf16_f32 v35, v150, v151
    v_mfma_f32_32x32x16_bf16 v[176:191], a[0:3], a[80:83], v[176:191]
    v_permlane32_swap_b32 v32, v34
    v_permlane32_swap_b32 v33, v35
    buffer_store_dwordx4 v[32:35], v28, s[44:47], s95 offen
    v_mfma_f32_32x32x16_bf16 v[176:191], a[8:11], a[84:87], v[176:191]
    v_mfma_f32_32x32x16_bf16 v[176:191], a[16:19], a[88:91], v[176:191]
    ds_write_b128 v24, v[192:195] offset:51200
    v_mfma_f32_32x32x16_bf16 v[176:191], a[24:27], a[92:95], v[176:191]
    ds_write_b128 v24, v[196:199] offset:52224
    ds_write_b128 v24, v[200:203] offset:55296
    ds_write_b128 v24, v[204:207] offset:56320
    s_nop 8
    ds_write_b128 v24, v[184:187] offset:53248
    ds_write_b128 v24, v[188:191] offset:54272
    s_waitcnt lgkmcnt(0)
    s_barrier
    ds_read_b128 v[216:219], v25 offset:49152
    ds_read_b128 v[220:223], v25 offset:50176
    ds_read_b128 v[224:227], v26 offset:49152
    ds_read_b128 v[228:231], v26 offset:50176
    ds_read_b128 v[232:235], v27 offset:49152
    ds_read_b128 v[236:239], v27 offset:50176
    s_waitcnt lgkmcnt(5)
    v_pk_add_f32 v[176:177], v[176:177], v[216:217]
    v_pk_add_f32 v[178:179], v[178:179], v[218:219]
    s_waitcnt lgkmcnt(4)
    v_pk_add_f32 v[180:181], v[180:181], v[220:221]
    v_pk_add_f32 v[182:183], v[182:183], v[222:223]
    s_waitcnt lgkmcnt(3)
    v_pk_add_f32 v[176:177], v[176:177], v[224:225]
    v_pk_add_f32 v[178:179], v[178:179], v[226:227]
    s_waitcnt lgkmcnt(2)
    v_pk_add_f32 v[180:181], v[180:181], v[228:229]
    v_pk_add_f32 v[182:183], v[182:183], v[230:231]
    s_waitcnt lgkmcnt(1)
    v_pk_add_f32 v[176:177], v[176:177], v[232:233]
    v_pk_add_f32 v[178:179], v[178:179], v[234:235]
    s_waitcnt lgkmcnt(0)
    v_pk_add_f32 v[180:181], v[180:181], v[236:237]
    v_pk_add_f32 v[182:183], v[182:183], v[238:239]
    v_cvt_pk_bf16_f32 v36, v176, v177
    v_cvt_pk_bf16_f32 v37, v178, v179
    v_cvt_pk_bf16_f32 v38, v180, v181
    v_cvt_pk_bf16_f32 v39, v182, v183
    s_add_u32 s95, s95, 28672
    v_permlane32_swap_b32 v36, v38
    v_permlane32_swap_b32 v37, v39
    buffer_store_dwordx4 v[36:39], v28, s[44:47], s95 offen
    s_endpgm
L_idle:
    s_waitcnt vmcnt(0)
    buffer_store_dword v2, v3, s[28:31], s24 offen sc1
    s_cmp_lg_u32 s2, 248
    s_cbranch_scc1 L_end
    s_cmp_lg_u32 s48, 0
    s_cbranch_scc1 L_end
    v_lshlrev_b32 v24, 7, v0
    s_mov_b32 s91, 0
L_ep:
    s_mov_b32 s60, 15794176
    buffer_load_dword v40, v24, s[28:31], s60 offen sc1
    s_mov_b32 s60, 15802368
    buffer_load_dword v41, v24, s[28:31], s60 offen sc1
    s_mov_b32 s60, 15810560
    buffer_load_dword v42, v24, s[28:31], s60 offen sc1
    s_mov_b32 s60, 15818752
    buffer_load_dword v43, v24, s[28:31], s60 offen sc1
    s_mov_b32 s60, 15826944
    buffer_load_dword v44, v24, s[28:31], s60 offen sc1
    s_mov_b32 s60, 15835136
    buffer_load_dword v45, v24, s[28:31], s60 offen sc1
    s_mov_b32 s60, 15843328
    buffer_load_dword v46, v24, s[28:31], s60 offen sc1
    s_mov_b32 s60, 15851520
    buffer_load_dword v47, v24, s[28:31], s60 offen sc1
    s_mov_b32 s60, 15859712
    buffer_load_dword v48, v24, s[28:31], s60 offen sc1
    s_mov_b32 s60, 15867904
    buffer_load_dword v49, v24, s[28:31], s60 offen sc1
    s_mov_b32 s60, 15876096
    buffer_load_dword v50, v24, s[28:31], s60 offen sc1
    s_mov_b32 s60, 15884288
    buffer_load_dword v51, v24, s[28:31], s60 offen sc1
    s_mov_b32 s60, 15892480
    buffer_load_dword v52, v24, s[28:31], s60 offen sc1
    s_mov_b32 s60, 15900672
    buffer_load_dword v53, v24, s[28:31], s60 offen sc1
    s_mov_b32 s60, 15908864
    buffer_load_dword v54, v24, s[28:31], s60 offen sc1
    s_mov_b32 s60, 15917056
    buffer_load_dword v55, v24, s[28:31], s60 offen sc1
    s_add_u32 s91, s91, 1
    s_waitcnt vmcnt(0)
    v_xor_b32 v40, v2, v40
    v_xor_b32 v41, v2, v41
    v_xor_b32 v42, v2, v42
    v_xor_b32 v43, v2, v43
    v_xor_b32 v44, v2, v44
    v_xor_b32 v45, v2, v45
    v_xor_b32 v46, v2, v46
    v_xor_b32 v47, v2, v47
    v_xor_b32 v48, v2, v48
    v_xor_b32 v49, v2, v49
    v_xor_b32 v50, v2, v50
    v_xor_b32 v51, v2, v51
    v_xor_b32 v52, v2, v52
    v_xor_b32 v53, v2, v53
    v_xor_b32 v54, v2, v54
    v_xor_b32 v55, v2, v55
    v_or_b32 v40, v40, v41
    v_or_b32 v40, v40, v42
    v_or_b32 v40, v40, v43
    v_or_b32 v40, v40, v44
    v_or_b32 v40, v40, v45
    v_or_b32 v40, v40, v46
    v_or_b32 v40, v40, v47
    v_or_b32 v40, v40, v48
    v_or_b32 v40, v40, v49
    v_or_b32 v40, v40, v50
    v_or_b32 v40, v40, v51
    v_or_b32 v40, v40, v52
    v_or_b32 v40, v40, v53
    v_or_b32 v40, v40, v54
    v_or_b32 v40, v40, v55
    v_cmp_ne_u32 vcc, 0, v40
    s_cmp_gt_u32 s91, 0x8000
    s_cbranch_scc1 L_epd
    s_cbranch_vccnz L_ep
L_epd:
    s_mov_b32 s60, 16252928
    buffer_store_dword v2, v3, s[28:31], s60 offen sc1
L_end:
    s_endpgm
L_pf1:
    v_min_u32 v30, 12, v0
    v_lshlrev_b32 v30, 7, v30
    buffer_load_dword a255, v30, s[16:19], s96 offen
    s_branch L_pfb1
L_pf2:
    v_min_u32 v30, 12, v0
    v_lshlrev_b32 v30, 7, v30
    buffer_load_dword a255, v30, s[16:19], s96 offen
    s_branch L_pfb2
L_pf3:
    v_min_u32 v30, 12, v0
    v_lshlrev_b32 v30, 7, v30
    buffer_load_dword a255, v30, s[16:19], s96 offen
    s_branch L_pfb3
L_pf4:
    v_min_u32 v30, 12, v0
    v_lshlrev_b32 v30, 7, v30
    buffer_load_dword a255, v30, s[16:19], s96 offen
    s_branch L_pfb4
L_pf5:
    v_min_u32 v30, 12, v0
    v_lshlrev_b32 v30, 7, v30
    buffer_load_dword a255, v30, s[16:19], s96 offen
    s_branch L_pfb5
L_pf6:
    v_min_u32 v30, 12, v0
    v_lshlrev_b32 v30, 7, v30
    buffer_load_dword a255, v30, s[20:23], s96 offen
    v_min_u32 v30, 3, v0
    v_lshlrev_b32 v30, 7, v30
    buffer_load_dword a255, v30, s[12:15], s97 offen
    s_branch L_pfb6
L_pf7:
    v_min_u32 v30, 12, v0
    v_lshlrev_b32 v30, 7, v30
    buffer_load_dword a255, v30, s[20:23], s96 offen
    v_min_u32 v30, 3, v0
    v_lshlrev_b32 v30, 7, v30
    buffer_load_dword a255, v30, s[12:15], s97 offen
    s_branch L_pfb7
L_pf8:
    v_min_u32 v30, 12, v0
    v_lshlrev_b32 v30, 7, v30
    buffer_load_dword a255, v30, s[20:23], s96 offen
    v_min_u32 v30, 3, v0
    v_lshlrev_b32 v30, 7, v30
    buffer_load_dword a255, v30, s[12:15], s97 offen
    s_branch L_pfb8
L_pf9:
    v_min_u32 v30, 12, v0
    v_lshlrev_b32 v30, 7, v30
    buffer_load_dword a255, v30, s[20:23], s96 offen
    v_min_u32 v30, 3, v0
    v_lshlrev_b32 v30, 7, v30
    buffer_load_dword a255, v30, s[12:15], s97 offen
    s_branch L_pfb9
L_pf10:
    v_min_u32 v30, 12, v0
    v_lshlrev_b32 v30, 7, v30
    buffer_load_dword a255, v30, s[20:23], s96 offen
    v_min_u32 v30, 3, v0
    v_lshlrev_b32 v30, 7, v30
    buffer_load_dword a255, v30, s[12:15], s97 offen
    s_branch L_pfb10
L_pf11:
    v_min_u32 v30, 12, v0
    v_lshlrev_b32 v30, 7, v30
    buffer_load_dword a255, v30, s[20:23], s96 offen
    v_min_u32 v30, 3, v0
    v_lshlrev_b32 v30, 7, v30
    buffer_load_dword a255, v30, s[12:15], s97 offen
    s_branch L_pfb11
L_pf12:
    v_min_u32 v30, 12, v0
    v_lshlrev_b32 v30, 7, v30
    buffer_load_dword a255, v30, s[20:23], s96 offen
    v_min_u32 v30, 3, v0
    v_lshlrev_b32 v30, 7, v30
    buffer_load_dword a255, v30, s[12:15], s97 offen
    s_branch L_pfb12
L_pf7l:
    v_min_u32 v30, 12, v0
    v_lshlrev_b32 v30, 7, v30
    buffer_load_dword a255, v30, s[20:23], s96 offen
    v_min_u32 v30, 3, v0
    v_lshlrev_b32 v30, 7, v30
    buffer_load_dword a255, v30, s[12:15], s97 offen
    s_branch L_pfb7l
L_pf8l:
    v_min_u32 v30, 12, v0
    v_lshlrev_b32 v30, 7, v30
    buffer_load_dword a255, v30, s[20:23], s96 offen
    v_min_u32 v30, 3, v0
    v_lshlrev_b32 v30, 7, v30
    buffer_load_dword a255, v30, s[12:15], s97 offen
    s_branch L_pfb8l
L_pf9l:
    v_min_u32 v30, 12, v0
    v_lshlrev_b32 v30, 7, v30
    buffer_load_dword a255, v30, s[20:23], s96 offen
    v_min_u32 v30, 3, v0
    v_lshlrev_b32 v30, 7, v30
    buffer_load_dword a255, v30, s[12:15], s97 offen
    s_branch L_pfb9l
L_pf10l:
    v_min_u32 v30, 12, v0
    v_lshlrev_b32 v30, 7, v30
    buffer_load_dword a255, v30, s[20:23], s96 offen
    v_min_u32 v30, 3, v0
    v_lshlrev_b32 v30, 7, v30
    buffer_load_dword a255, v30, s[12:15], s97 offen
    s_branch L_pfb10l
L_pf11l:
    v_min_u32 v30, 12, v0
    v_lshlrev_b32 v30, 7, v30
    buffer_load_dword a255, v30, s[20:23], s96 offen
    v_min_u32 v30, 3, v0
    v_lshlrev_b32 v30, 7, v30
    buffer_load_dword a255, v30, s[12:15], s97 offen
    s_branch L_pfb11l
L_pf12l:
    v_min_u32 v30, 12, v0
    v_lshlrev_b32 v30, 7, v30
    buffer_load_dword a255, v30, s[20:23], s96 offen
    v_min_u32 v30, 3, v0
    v_lshlrev_b32 v30, 7, v30
    buffer_load_dword a255, v30, s[12:15], s97 offen
    s_branch L_pfb12l
L_light:
    ds_read_b64_tr_b16 v[40:41], v6 offset:0
    ds_read_b64_tr_b16 v[42:43], v6 offset:768
    ds_read_b128 v[208:211], v36 offset:4096
    s_add_u32 m0, s78, 24576
    s_mul_i32 s76, s74, 172032
    buffer_load_dwordx4 v20, s[32:35], s76 offen lds
    s_waitcnt lgkmcnt(3)
    v_mfma_f32_32x32x16_bf16 v[64:79], v[52:55], v[204:207], v[64:79]
    ds_read_b64_tr_b16 v[44:45], v6 offset:56
    ds_read_b64_tr_b16 v[46:47], v6 offset:824
    ds_read_b128 v[212:215], v37 offset:4096
    buffer_load_dwordx4 v21, s[32:35], s76 offen offset:1024 lds
    v_mfma_f32_32x32x16_bf16 v[80:95], v[56:59], v[204:207], v[80:95]
    ds_read_b64_tr_b16 v[48:49], v6 offset:112
    ds_read_b64_tr_b16 v[50:51], v6 offset:880
    ds_read_b128 v[216:219], v38 offset:4096
    v_lshlrev_b32 v126, 16, v127
    v_and_b32 v127, 0xffff0000, v127
    v_mfma_f32_32x32x16_bf16 v[96:111], v[60:63], v[204:207], v[96:111]
    ds_read_b64_tr_b16 v[52:53], v6 offset:3072
    ds_read_b64_tr_b16 v[54:55], v6 offset:3840
    ds_read_b128 v[220:223], v39 offset:4096
    buffer_load_dwordx4 v22, s[32:35], s76 offen offset:2048 lds
    s_cmp_eq_u32 s99, 1
    s_cbranch_scc1 L_pf7l
L_pfb7l:
    s_waitcnt lgkmcnt(4)
    v_mfma_f32_32x32x16_bf16 v[64:79], v[40:43], v[208:211], v[64:79]
    ds_read_b64_tr_b16 v[56:57], v6 offset:3128
    ds_read_b64_tr_b16 v[58:59], v6 offset:3896
    s_mov_b32 m0, s3
    s_lshl_b32 s75, s74, 7
    buffer_load_dwordx4 v32, s[8:11], s75 offen lds
    v_mfma_f32_32x32x16_bf16 v[80:95], v[44:47], v[208:211], v[80:95]
    ds_read_b64_tr_b16 v[60:61], v6 offset:3184
    ds_read_b64_tr_b16 v[62:63], v6 offset:3952
    v_lshlrev_b32 v128, 16, v136
    v_and_b32 v129, 0xffff0000, v136
    v_lshlrev_b32 v130, 16, v137
    v_mfma_f32_32x32x16_bf16 v[96:111], v[48:51], v[208:211], v[96:111]
    ds_read_b64_tr_b16 v[40:41], v6 offset:6144
    ds_read_b64_tr_b16 v[42:43], v6 offset:6912
    buffer_load_dwordx4 v33, s[8:11], s75 offen offset:1024 lds
    v_and_b32 v131, 0xffff0000, v137
    s_waitcnt lgkmcnt(2)
    v_mfma_f32_32x32x16_bf16 v[64:79], v[52:55], v[212:215], v[64:79]
    ds_read_b64_tr_b16 v[44:45], v6 offset:6200
    ds_read_b64_tr_b16 v[46:47], v6 offset:6968
    buffer_load_dwordx4 v34, s[8:11], s75 offen offset:2048 lds
    v_lshlrev_b32 v132, 16, v138
    v_mfma_f32_32x32x16_bf16 v[80:95], v[56:59], v[212:215], v[80:95]
    ds_read_b64_tr_b16 v[48:49], v6 offset:6256
    ds_read_b64_tr_b16 v[50:51], v6 offset:7024
    buffer_load_dwordx4 v35, s[8:11], s75 offen offset:3072 lds
    v_and_b32 v133, 0xffff0000, v138
    v_mfma_f32_32x32x16_bf16 v[96:111], v[60:63], v[212:215], v[96:111]
    ds_read_b64_tr_b16 v[52:53], v6 offset:9216
    ds_read_b64_tr_b16 v[54:55], v6 offset:9984
    v_lshlrev_b32 v134, 16, v139
    v_and_b32 v135, 0xffff0000, v139
    v_lshlrev_b32 v136, 16, v140
    s_cmp_eq_u32 s99, 2
    s_cbranch_scc1 L_pf8l
L_pfb8l:
    s_waitcnt lgkmcnt(2)
    v_mfma_f32_32x32x16_bf16 v[64:79], v[40:43], v[216:219], v[64:79]
    ds_read_b64_tr_b16 v[56:57], v6 offset:9272
    ds_read_b64_tr_b16 v[58:59], v6 offset:10040
    v_mfma_f32_32x32x16_bf16 v[80:95], v[44:47], v[216:219], v[80:95]
    ds_read_b64_tr_b16 v[60:61], v6 offset:9328
    ds_read_b64_tr_b16 v[62:63], v6 offset:10096
    v_and_b32 v137, 0xffff0000, v140
    v_mfma_f32_32x32x16_bf16 v[96:111], v[48:51], v[216:219], v[96:111]
    s_waitcnt vmcnt(7)
    s_barrier
    ds_read_b64_tr_b16 v[40:41], v6 offset:12288
    ds_read_b64_tr_b16 v[42:43], v6 offset:13056
    ds_read_b128 v[224:227], v36 offset:8192
    s_waitcnt lgkmcnt(3)
    v_mfma_f32_32x32x16_bf16 v[64:79], v[52:55], v[220:223], v[64:79]
    ds_read_b64_tr_b16 v[44:45], v6 offset:12344
    ds_read_b64_tr_b16 v[46:47], v6 offset:13112
    ds_read_b128 v[228:231], v37 offset:8192
    v_mfma_f32_32x32x16_bf16 v[80:95], v[56:59], v[220:223], v[80:95]
    ds_read_b64_tr_b16 v[48:49], v6 offset:12400
    ds_read_b64_tr_b16 v[50:51], v6 offset:13168
    ds_read_b128 v[232:235], v38 offset:8192
    v_mfma_f32_32x32x16_bf16 v[96:111], v[60:63], v[220:223], v[96:111]
    ds_read_b64_tr_b16 v[52:53], v6 offset:15360
    ds_read_b64_tr_b16 v[54:55], v6 offset:16128
    ds_read_b128 v[236:239], v39 offset:8192
    s_cmp_eq_u32 s99, 3
    s_cbranch_scc1 L_pf9l
L_pfb9l:
    s_waitcnt lgkmcnt(4)
    v_mfma_f32_32x32x16_bf16 v[64:79], v[40:43], v[224:227], v[64:79]
    ds_read_b64_tr_b16 v[56:57], v6 offset:15416
    ds_read_b64_tr_b16 v[58:59], v6 offset:16184
    v_lshlrev_b32 v138, 16, v141
    v_and_b32 v139, 0xffff0000, v141
    v_lshlrev_b32 v140, 16, v142
    v_mfma_f32_32x32x16_bf16 v[80:95], v[44:47], v[224:227], v[80:95]
    ds_read_b64_tr_b16 v[60:61], v6 offset:15472
    ds_read_b64_tr_b16 v[62:63], v6 offset:16240
    v_mfma_f32_32x32x16_bf16 v[96:111], v[48:51], v[224:227], v[96:111]
    ds_read_b64_tr_b16 v[40:41], v6 offset:18432
    ds_read_b64_tr_b16 v[42:43], v6 offset:19200
    v_and_b32 v141, 0xffff0000, v142
    s_waitcnt lgkmcnt(2)
    v_mfma_f32_32x32x16_bf16 v[64:79], v[52:55], v[228:231], v[64:79]
    ds_read_b64_tr_b16 v[44:45], v6 offset:18488
    ds_read_b64_tr_b16 v[46:47], v6 offset:19256
    v_mfma_f32_32x32x16_bf16 v[80:95], v[56:59], v[228:231], v[80:95]
    ds_read_b64_tr_b16 v[48:49], v6 offset:18544
    ds_read_b64_tr_b16 v[50:51], v6 offset:19312
    v_lshlrev_b32 v142, 16, v143
    v_and_b32 v143, 0xffff0000, v143
    v_mfma_f32_32x32x16_bf16 v[96:111], v[60:63], v[228:231], v[96:111]
    ds_read_b64_tr_b16 v[52:53], v6 offset:21504
    ds_read_b64_tr_b16 v[54:55], v6 offset:22272
    s_cmp_eq_u32 s99, 4
    s_cbranch_scc1 L_pf10l
L_pfb10l:
    s_waitcnt lgkmcnt(2)
    v_mfma_f32_32x32x16_bf16 v[64:79], v[40:43], v[232:235], v[64:79]
    ds_read_b64_tr_b16 v[56:57], v6 offset:21560
    ds_read_b64_tr_b16 v[58:59], v6 offset:22328
    v_mfma_f32_32x32x16_bf16 v[80:95], v[44:47], v[232:235], v[80:95]
    ds_read_b64_tr_b16 v[60:61], v6 offset:21616
    ds_read_b64_tr_b16 v[62:63], v6 offset:22384
    v_mfma_f32_32x32x16_bf16 v[96:111], v[48:51], v[232:235], v[96:111]
    s_waitcnt vmcnt(0)
    s_barrier
    ds_read_b64_tr_b16 v[40:41], v6 offset:24576
    ds_read_b64_tr_b16 v[42:43], v6 offset:25344
    ds_read_b128 v[240:243], v36 offset:0
    s_waitcnt lgkmcnt(3)
    v_mfma_f32_32x32x16_bf16 v[64:79], v[52:55], v[236:239], v[64:79]
    ds_read_b64_tr_b16 v[44:45], v6 offset:24632
    ds_read_b64_tr_b16 v[46:47], v6 offset:25400
    ds_read_b128 v[244:247], v37 offset:0
    v_mfma_f32_32x32x16_bf16 v[80:95], v[56:59], v[236:239], v[80:95]
    ds_read_b64_tr_b16 v[48:49], v6 offset:24688
    ds_read_b64_tr_b16 v[50:51], v6 offset:25456
    ds_read_b128 v[248:251], v38 offset:0
    v_mfma_f32_32x32x16_bf16 v[96:111], v[60:63], v[236:239], v[96:111]
    ds_read_b64_tr_b16 v[52:53], v6 offset:27648
    ds_read_b64_tr_b16 v[54:55], v6 offset:28416
    ds_read_b128 v[252:255], v39 offset:0
    s_cmp_eq_u32 s99, 5
    s_cbranch_scc1 L_pf11l
L_pfb11l:
    s_waitcnt lgkmcnt(4)
    v_mfma_f32_32x32x16_bf16 v[64:79], v[40:43], v[240:243], v[64:79]
    ds_read_b64_tr_b16 v[56:57], v6 offset:27704
    ds_read_b64_tr_b16 v[58:59], v6 offset:28472
    v_mfma_f32_32x32x16_bf16 v[80:95], v[44:47], v[240:243], v[80:95]
    ds_read_b64_tr_b16 v[60:61], v6 offset:27760
    ds_read_b64_tr_b16 v[62:63], v6 offset:28528
    v_mfma_f32_32x32x16_bf16 v[96:111], v[48:51], v[240:243], v[96:111]
    ds_read_b64_tr_b16 v[40:41], v6 offset:30720
    ds_read_b64_tr_b16 v[42:43], v6 offset:31488
    s_waitcnt lgkmcnt(2)
    v_mfma_f32_32x32x16_bf16 v[64:79], v[52:55], v[244:247], v[64:79]
    ds_read_b64_tr_b16 v[44:45], v6 offset:30776
    ds_read_b64_tr_b16 v[46:47], v6 offset:31544
    v_mfma_f32_32x32x16_bf16 v[80:95], v[56:59], v[244:247], v[80:95]
    ds_read_b64_tr_b16 v[48:49], v6 offset:30832
    ds_read_b64_tr_b16 v[50:51], v6 offset:31600
    v_mfma_f32_32x32x16_bf16 v[96:111], v[60:63], v[244:247], v[96:111]
    ds_read_b64_tr_b16 v[52:53], v6 offset:33792
    ds_read_b64_tr_b16 v[54:55], v6 offset:34560
    s_cmp_eq_u32 s99, 6
    s_cbranch_scc1 L_pf12l
L_pfb12l:
    s_waitcnt lgkmcnt(2)
    v_mfma_f32_32x32x16_bf16 v[64:79], v[40:43], v[248:251], v[64:79]
    ds_read_b64_tr_b16 v[56:57], v6 offset:33848
    ds_read_b64_tr_b16 v[58:59], v6 offset:34616
    v_mfma_f32_32x32x16_bf16 v[80:95], v[44:47], v[248:251], v[80:95]
    ds_read_b64_tr_b16 v[60:61], v6 offset:33904
    ds_read_b64_tr_b16 v[62:63], v6 offset:34672
    v_mfma_f32_32x32x16_bf16 v[96:111], v[48:51], v[248:251], v[96:111]
    s_waitcnt lgkmcnt(0)
    s_barrier
    ds_read_b64_tr_b16 v[40:41], v7 offset:0
    ds_read_b64_tr_b16 v[42:43], v7 offset:512
    v_mfma_f32_32x32x16_bf16 v[64:79], v[52:55], v[252:255], v[64:79]
    v_mfma_f32_32x32x16_bf16 v[80:95], v[56:59], v[252:255], v[80:95]
    ds_read_b64_tr_b16 v[48:49], v7 offset:2048
    ds_read_b64_tr_b16 v[50:51], v7 offset:2560
    v_mfma_f32_32x32x16_bf16 v[96:111], v[60:63], v[252:255], v[96:111]
    s_cmp_lt_u32 s56, 28
    s_cselect_b32 s22, 1605632, 0
    s_cselect_b32 s14, 401408, 0
    s_waitcnt lgkmcnt(2)
    v_mfma_f32_32x32x16_bf16 v[112:127], v[40:43], v[144:147], v[112:127]
    ds_read_b64_tr_b16 v[56:57], v7 offset:4096
    ds_read_b64_tr_b16 v[58:59], v7 offset:4608
    s_mov_b32 m0, s81
    s_mul_i32 s76, s68, 229376
    s_add_u32 s76, s76, s52
    buffer_load_dwordx4 v9, s[16:19], s76 offen lds
    buffer_load_dwordx4 v10, s[16:19], s76 offen offset:1024 lds
    s_movk_i32 s63, 0x3f80
    s_waitcnt lgkmcnt(2)
    v_mfma_f32_32x32x16_bf16 v[112:127], v[48:51], v[148:151], v[112:127]
    ds_read_b64_tr_b16 v[40:41], v7 offset:6144
    ds_read_b64_tr_b16 v[42:43], v7 offset:6656
    s_add_u32 m0, s81, 8192
    s_mul_i32 s76, s69, 229376
    s_add_u32 s76, s76, s52
    buffer_load_dwordx4 v9, s[16:19], s76 offen lds
    buffer_load_dwordx4 v10, s[16:19], s76 offen offset:1024 lds
    s_waitcnt lgkmcnt(2)
    v_mfma_f32_32x32x16_bf16 v[112:127], v[56:59], v[152:155], v[112:127]
    ds_read_b64_tr_b16 v[48:49], v7 offset:8192
    ds_read_b64_tr_b16 v[50:51], v7 offset:8704
    s_cmp_gt_i32 s94, -14
    s_cselect_b32 s60, 0x3f803f80, s63
    s_cselect_b32 s62, s63, 0
    s_add_u32 m0, s82, 49152
    s_nop 0
    buffer_load_dwordx4 v12, s[20:23], s83 offen lds
    s_waitcnt lgkmcnt(2)
    v_mfma_f32_32x32x16_bf16 v[112:127], v[40:43], v[156:159], v[112:127]
    ds_read_b64_tr_b16 v[56:57], v7 offset:10240
    ds_read_b64_tr_b16 v[58:59], v7 offset:10752
    buffer_load_dwordx4 v13, s[20:23], s83 offen offset:1024 lds
    s_cmp_gt_i32 s94, 2
    s_cselect_b32 s61, 1049335798, 1.0
    s_cselect_b32 s60, 0, s60
    s_cselect_b32 s62, 0, s62
    s_waitcnt lgkmcnt(2)
    v_mfma_f32_32x32x16_bf16 v[112:127], v[48:51], v[160:163], v[112:127]
    ds_read_b64_tr_b16 v[40:41], v7 offset:12288
    ds_read_b64_tr_b16 v[42:43], v7 offset:12800
    buffer_load_dwordx4 v14, s[20:23], s83 offen offset:2048 lds
    v_mov_b32 v28, s60
    buffer_load_dwordx4 v15, s[20:23], s83 offen offset:3072 lds
    v_mov_b32 v29, s62
    s_waitcnt lgkmcnt(2)
    v_mfma_f32_32x32x16_bf16 v[112:127], v[56:59], v[164:167], v[112:127]
    ds_read_b64_tr_b16 v[48:49], v7 offset:14336
    ds_read_b64_tr_b16 v[50:51], v7 offset:14848
    s_add_u32 m0, s82, 53248
    s_add_u32 s83, s83, s77
    buffer_load_dwordx4 v12, s[20:23], s83 offen lds
    v_mul_f32 v96, s61, v96
    v_mul_f32 v97, s61, v97
    v_mul_f32 v98, s61, v98
    s_waitcnt lgkmcnt(2)
    v_mfma_f32_32x32x16_bf16 v[112:127], v[40:43], v[168:171], v[112:127]
    ds_read_b64_tr_b16 v[56:57], v7 offset:16384
    ds_read_b64_tr_b16 v[58:59], v7 offset:16896
    v_mul_f32 v99, s61, v99
    v_mul_f32 v100, s61, v100
    v_mul_f32 v101, s61, v101
    v_mul_f32 v102, s61, v102
    v_mul_f32 v103, s61, v103
    v_mul_f32 v104, s61, v104
    s_waitcnt lgkmcnt(2)
    v_mfma_f32_32x32x16_bf16 v[112:127], v[48:51], v[172:175], v[112:127]
    ds_read_b64_tr_b16 v[40:41], v7 offset:18432
    ds_read_b64_tr_b16 v[42:43], v7 offset:18944
    v_mul_f32 v105, s61, v105
    v_mul_f32 v106, s61, v106
    v_mul_f32 v107, s61, v107
    v_mul_f32 v108, s61, v108
    v_mul_f32 v109, s61, v109
    v_mul_f32 v110, s61, v110
    s_waitcnt lgkmcnt(2)
    v_mfma_f32_32x32x16_bf16 v[112:127], v[56:59], v[176:179], v[112:127]
    ds_read_b64_tr_b16 v[48:49], v7 offset:20480
    ds_read_b64_tr_b16 v[50:51], v7 offset:20992
    buffer_load_dwordx4 v13, s[20:23], s83 offen offset:1024 lds
    v_mul_f32 v111, s61, v111
    buffer_load_dwordx4 v14, s[20:23], s83 offen offset:2048 lds
    v_cvt_pk_bf16_f32 v96, v96, v97
    s_waitcnt lgkmcnt(2)
    v_mfma_f32_32x32x16_bf16 v[112:127], v[40:43], v[180:183], v[112:127]
    ds_read_b64_tr_b16 v[56:57], v7 offset:22528
    ds_read_b64_tr_b16 v[58:59], v7 offset:23040
    buffer_load_dwordx4 v15, s[20:23], s83 offen offset:3072 lds
    v_cvt_pk_bf16_f32 v97, v98, v99
    v_cvt_pk_bf16_f32 v98, v100, v101
    v_cvt_pk_bf16_f32 v99, v102, v103
    v_cvt_pk_bf16_f32 v100, v104, v105
    s_waitcnt lgkmcnt(2)
    v_mfma_f32_32x32x16_bf16 v[112:127], v[48:51], v[184:187], v[112:127]
    s_barrier
    ds_read_b64_tr_b16 v[40:41], v7 offset:24576
    ds_read_b64_tr_b16 v[42:43], v7 offset:25088
    s_add_u32 s75, s0, 262144
    buffer_store_dwordx4 v[96:99], v26, s[28:31], s75 offen offset:0 sc1
    s_add_u32 m0, s82, 57344
    s_add_u32 s83, s83, s77
    buffer_load_dwordx4 v12, s[20:23], s83 offen lds
    s_waitcnt lgkmcnt(2)
    v_mfma_f32_32x32x16_bf16 v[112:127], v[56:59], v[188:191], v[112:127]
    ds_read_b64_tr_b16 v[48:49], v7 offset:26624
    ds_read_b64_tr_b16 v[50:51], v7 offset:27136
    v_cvt_pk_bf16_f32 v101, v106, v107
    v_cvt_pk_bf16_f32 v102, v108, v109
    v_cvt_pk_bf16_f32 v103, v110, v111
    v_cndmask_b32 v102, v102, v28, s[64:65]
    v_cndmask_b32 v103, v103, v29, s[64:65]
    s_waitcnt lgkmcnt(2)
    v_mfma_f32_32x32x16_bf16 v[112:127], v[40:43], v[192:195], v[112:127]
    ds_read_b64_tr_b16 v[56:57], v7 offset:28672
    ds_read_b64_tr_b16 v[58:59], v7 offset:29184
    buffer_store_dwordx4 v[100:103], v27, s[28:31], s75 offen offset:1024 sc1
    s_cmp_gt_i32 s94, -15
    s_cselect_b32 s60, 0x3f803f80, s63
    s_cselect_b32 s62, s63, 0
    s_waitcnt lgkmcnt(2)
    v_mfma_f32_32x32x16_bf16 v[112:127], v[48:51], v[196:199], v[112:127]
    ds_read_b64_tr_b16 v[40:41], v7 offset:30720
    ds_read_b64_tr_b16 v[42:43], v7 offset:31232
    buffer_load_dwordx4 v13, s[20:23], s83 offen offset:1024 lds
    s_cmp_gt_i32 s94, 1
    s_cselect_b32 s61, 1049335798, 1.0
    s_cselect_b32 s60, 0, s60
    s_cselect_b32 s62, 0, s62
    s_waitcnt lgkmcnt(2)
    v_mfma_f32_32x32x16_bf16 v[112:127], v[56:59], v[200:203], v[112:127]
    ds_read_b64_tr_b16 v[48:49], v7 offset:32768
    ds_read_b64_tr_b16 v[50:51], v7 offset:33280
    v_mov_b32 v28, s60
    v_mov_b32 v29, s62
    v_mul_f32 v80, s61, v80
    buffer_load_dwordx4 v14, s[20:23], s83 offen offset:2048 lds
    v_mul_f32 v81, s61, v81
    s_waitcnt lgkmcnt(2)
    v_mfma_f32_32x32x16_bf16 v[112:127], v[40:43], v[204:207], v[112:127]
    ds_read_b64_tr_b16 v[56:57], v7 offset:34816
    ds_read_b64_tr_b16 v[58:59], v7 offset:35328
    buffer_load_dwordx4 v15, s[20:23], s83 offen offset:3072 lds
    v_mul_f32 v82, s61, v82
    v_mul_f32 v83, s61, v83
    v_mul_f32 v84, s61, v84
    v_mul_f32 v85, s61, v85
    s_waitcnt lgkmcnt(2)
    v_mfma_f32_32x32x16_bf16 v[112:127], v[48:51], v[208:211], v[112:127]
    ds_read_b64_tr_b16 v[40:41], v7 offset:36864
    ds_read_b64_tr_b16 v[42:43], v7 offset:37376
    v_mul_f32 v86, s61, v86
    v_mul_f32 v87, s61, v87
    v_mul_f32 v88, s61, v88
    v_mul_f32 v89, s61, v89
    v_mul_f32 v90, s61, v90
    v_mul_f32 v91, s61, v91
    s_waitcnt lgkmcnt(2)
    v_mfma_f32_32x32x16_bf16 v[112:127], v[56:59], v[212:215], v[112:127]
    ds_read_b64_tr_b16 v[48:49], v7 offset:38912
    ds_read_b64_tr_b16 v[50:51], v7 offset:39424
    v_mul_f32 v92, s61, v92
    v_mul_f32 v93, s61, v93
    v_mul_f32 v94, s61, v94
    v_mul_f32 v95, s61, v95
    v_cvt_pk_bf16_f32 v104, v80, v81
    v_cvt_pk_bf16_f32 v105, v82, v83
    s_waitcnt lgkmcnt(2)
    v_mfma_f32_32x32x16_bf16 v[112:127], v[40:43], v[216:219], v[112:127]
    ds_read_b64_tr_b16 v[56:57], v7 offset:40960
    ds_read_b64_tr_b16 v[58:59], v7 offset:41472
    v_cvt_pk_bf16_f32 v106, v84, v85
    v_cvt_pk_bf16_f32 v107, v86, v87
    v_cvt_pk_bf16_f32 v108, v88, v89
    s_add_u32 s75, s0, 131072
    buffer_store_dwordx4 v[104:107], v24, s[28:31], s75 offen offset:0 sc1
    s_waitcnt lgkmcnt(2)
    v_mfma_f32_32x32x16_bf16 v[112:127], v[48:51], v[220:223], v[112:127]
    ds_read_b64_tr_b16 v[40:41], v7 offset:43008
    ds_read_b64_tr_b16 v[42:43], v7 offset:43520
    v_cvt_pk_bf16_f32 v109, v90, v91
    v_cvt_pk_bf16_f32 v110, v92, v93
    v_cvt_pk_bf16_f32 v111, v94, v95
    v_cndmask_b32 v110, v110, v28, s[64:65]
    v_cndmask_b32 v111, v111, v29, s[64:65]
    s_waitcnt lgkmcnt(2)
    v_mfma_f32_32x32x16_bf16 v[112:127], v[56:59], v[224:227], v[112:127]
    ds_read_b64_tr_b16 v[48:49], v7 offset:45056
    ds_read_b64_tr_b16 v[50:51], v7 offset:45568
    buffer_store_dwordx4 v[108:111], v25, s[28:31], s75 offen offset:1024 sc1
    s_cmp_gt_i32 s94, -16
    s_cselect_b32 s60, 0x3f803f80, s63
    s_cselect_b32 s62, s63, 0
    s_waitcnt lgkmcnt(2)
    v_mfma_f32_32x32x16_bf16 v[112:127], v[40:43], v[228:231], v[112:127]
    ds_read_b64_tr_b16 v[56:57], v7 offset:47104
    ds_read_b64_tr_b16 v[58:59], v7 offset:47616
    s_cmp_gt_i32 s94, 0
    s_cselect_b32 s61, 1049335798, 1.0
    s_cselect_b32 s60, 0, s60
    s_cselect_b32 s62, 0, s62
    v_mov_b32 v28, s60
    v_mov_b32 v29, s62
    v_mul_f32 v64, s61, v64
    s_waitcnt lgkmcnt(2)
    v_mfma_f32_32x32x16_bf16 v[112:127], v[48:51], v[232:235], v[112:127]
    ds_read_b64_tr_b16 v[40:41], v7 offset:49152
    ds_read_b64_tr_b16 v[42:43], v7 offset:49664
    v_mul_f32 v65, s61, v65
    v_mul_f32 v66, s61, v66
    v_mul_f32 v67, s61, v67
    v_mul_f32 v68, s61, v68
    v_mul_f32 v69, s61, v69
    v_mul_f32 v70, s61, v70
    s_waitcnt lgkmcnt(2)
    v_mfma_f32_32x32x16_bf16 v[112:127], v[56:59], v[236:239], v[112:127]
    ds_read_b64_tr_b16 v[48:49], v7 offset:51200
    ds_read_b64_tr_b16 v[50:51], v7 offset:51712
    v_mul_f32 v71, s61, v71
    v_mul_f32 v72, s61, v72
    v_mul_f32 v73, s61, v73
    v_mul_f32 v74, s61, v74
    v_mul_f32 v75, s61, v75
    v_mul_f32 v76, s61, v76
    s_waitcnt lgkmcnt(2)
    v_mfma_f32_32x32x16_bf16 v[112:127], v[40:43], v[240:243], v[112:127]
    ds_read_b64_tr_b16 v[56:57], v7 offset:53248
    ds_read_b64_tr_b16 v[58:59], v7 offset:53760
    v_mul_f32 v77, s61, v77
    v_mul_f32 v78, s61, v78
    v_mul_f32 v79, s61, v79
    v_cvt_pk_bf16_f32 v32, v64, v65
    v_cvt_pk_bf16_f32 v33, v66, v67
    v_cvt_pk_bf16_f32 v34, v68, v69
    s_waitcnt lgkmcnt(2)
    v_mfma_f32_32x32x16_bf16 v[112:127], v[48:51], v[244:247], v[112:127]
    ds_read_b64_tr_b16 v[40:41], v7 offset:55296
    ds_read_b64_tr_b16 v[42:43], v7 offset:55808
    v_cvt_pk_bf16_f32 v35, v70, v71
    v_cvt_pk_bf16_f32 v36, v72, v73
    v_cvt_pk_bf16_f32 v37, v74, v75
    s_add_u32 s75, s0, 0
    buffer_store_dwordx4 v[32:35], v24, s[28:31], s75 offen offset:0 sc1
    s_waitcnt lgkmcnt(2)
    v_mfma_f32_32x32x16_bf16 v[112:127], v[56:59], v[248:251], v[112:127]
    v_cvt_pk_bf16_f32 v38, v76, v77
    v_cvt_pk_bf16_f32 v39, v78, v79
    v_cndmask_b32 v38, v38, v28, s[64:65]
    v_cndmask_b32 v39, v39, v29, s[64:65]
    buffer_store_dwordx4 v[36:39], v25, s[28:31], s75 offen offset:1024 sc1
    ds_read2_b64 v[72:75], v23 offset0:208 offset1:210
    ds_read2_b64 v[76:79], v23 offset0:212 offset1:214
    ds_read2_b64 v[88:91], v23 offset0:216 offset1:218
    ds_read2_b64 v[92:95], v23 offset0:220 offset1:222
    s_waitcnt lgkmcnt(3)
    v_lshlrev_b32 v64, 16, v72
    s_add_u32 m0, s81, 16384
    s_mul_i32 s76, s70, 229376
    s_add_u32 s76, s76, s52
    buffer_load_dwordx4 v9, s[16:19], s76 offen lds
    v_and_b32 v65, 0xffff0000, v72
    v_lshlrev_b32 v66, 16, v73
    v_and_b32 v67, 0xffff0000, v73
    v_lshlrev_b32 v68, 16, v74
    v_and_b32 v69, 0xffff0000, v74
    v_lshlrev_b32 v70, 16, v75
    v_and_b32 v71, 0xffff0000, v75
    s_waitcnt lgkmcnt(2)
    v_lshlrev_b32 v72, 16, v76
    v_and_b32 v73, 0xffff0000, v76
    v_lshlrev_b32 v74, 16, v77
    v_and_b32 v75, 0xffff0000, v77
    v_lshlrev_b32 v76, 16, v78
    v_and_b32 v77, 0xffff0000, v78
    v_lshlrev_b32 v78, 16, v79
    v_and_b32 v79, 0xffff0000, v79
    s_waitcnt lgkmcnt(1)
    v_lshlrev_b32 v80, 16, v88
    buffer_load_dwordx4 v10, s[16:19], s76 offen offset:1024 lds
    v_and_b32 v81, 0xffff0000, v88
    v_lshlrev_b32 v82, 16, v89
    v_and_b32 v83, 0xffff0000, v89
    v_lshlrev_b32 v84, 16, v90
    v_and_b32 v85, 0xffff0000, v90
    v_lshlrev_b32 v86, 16, v91
    v_and_b32 v87, 0xffff0000, v91
    s_waitcnt lgkmcnt(0)
    v_lshlrev_b32 v88, 16, v92
    s_add_u32 m0, s81, 24576
    s_mul_i32 s76, s71, 229376
    s_add_u32 s76, s76, s52
    buffer_load_dwordx4 v9, s[16:19], s76 offen lds
    v_and_b32 v89, 0xffff0000, v92
    v_lshlrev_b32 v90, 16, v93
    v_and_b32 v91, 0xffff0000, v93
    v_lshlrev_b32 v92, 16, v94
    v_and_b32 v93, 0xffff0000, v94
    buffer_load_dwordx4 v10, s[16:19], s76 offen offset:1024 lds
    v_lshlrev_b32 v94, 16, v95
    v_and_b32 v95, 0xffff0000, v95
    s_waitcnt vmcnt(22)
    s_barrier
    s_branch L_heavy
L_slow13:
    s_mov_b32 s91, 0
L_spin13:
    buffer_load_dword v20, v18, s[28:31], 0 offen sc1
    s_add_u32 s91, s91, 1
    s_waitcnt vmcnt(0)
    v_cmp_ne_u32 vcc, v2, v20
    s_cmp_gt_u32 s91, 0x20000
    s_cbranch_scc1 L_back13
    s_cbranch_vccnz L_spin13
    s_branch L_back13
L_pat14:
    s_nop 7
    v_mov_b32 v176, 0
    v_mov_b32 v177, 0
    v_mov_b32 v178, 0
    v_mov_b32 v179, 0
    v_mov_b32 v180, 0
    v_mov_b32 v181, 0
    v_mov_b32 v182, 0
    v_mov_b32 v183, 0
    v_mov_b32 v184, 0
    v_mov_b32 v185, 0
    v_mov_b32 v186, 0
    v_mov_b32 v187, 0
    v_mov_b32 v188, 0
    v_mov_b32 v189, 0
    v_mov_b32 v190, 0
    v_mov_b32 v191, 0
    s_nop 1
    s_branch L_patb14
L_pat15:
    s_nop 7
    v_mov_b32 v176, 0
    v_mov_b32 v177, 0
    v_mov_b32 v178, 0
    v_mov_b32 v179, 0
    v_mov_b32 v180, 0
    v_mov_b32 v181, 0
    v_mov_b32 v182, 0
    v_mov_b32 v183, 0
    v_mov_b32 v184, 0
    v_mov_b32 v185, 0
    v_mov_b32 v186, 0
    v_mov_b32 v187, 0
    v_mov_b32 v188, 0
    v_mov_b32 v189, 0
    v_mov_b32 v190, 0
    v_mov_b32 v191, 0
    s_nop 1
    s_branch L_patb15
L_pat16:
    s_nop 7
    v_mov_b32 v176, 0
    v_mov_b32 v177, 0
    v_mov_b32 v178, 0
    v_mov_b32 v179, 0
    v_mov_b32 v180, 0
    v_mov_b32 v181, 0
    v_mov_b32 v182, 0
    v_mov_b32 v183, 0
    v_mov_b32 v184, 0
    v_mov_b32 v185, 0
    v_mov_b32 v186, 0
    v_mov_b32 v187, 0
    v_mov_b32 v188, 0
    v_mov_b32 v189, 0
    v_mov_b32 v190, 0
    v_mov_b32 v191, 0
    s_nop 1
    s_branch L_patb16
L_pat17:
    s_nop 7
    v_mov_b32 v176, 0
    v_mov_b32 v177, 0
    v_mov_b32 v178, 0
    v_mov_b32 v179, 0
    v_mov_b32 v180, 0
    v_mov_b32 v181, 0
    v_mov_b32 v182, 0
    v_mov_b32 v183, 0
    v_mov_b32 v184, 0
    v_mov_b32 v185, 0
    v_mov_b32 v186, 0
    v_mov_b32 v187, 0
    v_mov_b32 v188, 0
    v_mov_b32 v189, 0
    v_mov_b32 v190, 0
    v_mov_b32 v191, 0
    s_nop 1
    s_branch L_patb17
L_pat18:
    s_nop 7
    v_mov_b32 v176, 0
    v_mov_b32 v177, 0
    v_mov_b32 v178, 0
    v_mov_b32 v179, 0
    v_mov_b32 v180, 0
    v_mov_b32 v181, 0
    v_mov_b32 v182, 0
    v_mov_b32 v183, 0
    v_mov_b32 v184, 0
    v_mov_b32 v185, 0
    v_mov_b32 v186, 0
    v_mov_b32 v187, 0
    v_mov_b32 v188, 0
    v_mov_b32 v189, 0
    v_mov_b32 v190, 0
    v_mov_b32 v191, 0
    s_nop 1
    s_branch L_patb18
L_pat19:
    s_nop 7
    v_mov_b32 v176, 0
    v_mov_b32 v177, 0
    v_mov_b32 v178, 0
    v_mov_b32 v179, 0
    v_mov_b32 v180, 0
    v_mov_b32 v181, 0
    v_mov_b32 v182, 0
    v_mov_b32 v183, 0
    v_mov_b32 v184, 0
    v_mov_b32 v185, 0
    v_mov_b32 v186, 0
    v_mov_b32 v187, 0
    v_mov_b32 v188, 0
    v_mov_b32 v189, 0
    v_mov_b32 v190, 0
    v_mov_b32 v191, 0
    s_nop 1
    s_branch L_patb19
L_pat20:
    s_nop 7
    v_mov_b32 v176, v255
    v_mov_b32 v177, v255
    v_mov_b32 v178, v255
    v_mov_b32 v179, v255
    v_mov_b32 v180, v255
    v_mov_b32 v181, v255
    v_mov_b32 v182, v255
    v_mov_b32 v183, v255
    v_mov_b32 v184, v255
    v_mov_b32 v185, v255
    v_mov_b32 v186, v255
    v_mov_b32 v187, v255
    v_mov_b32 v188, v255
    v_mov_b32 v189, v255
    v_mov_b32 v190, v255
    v_mov_b32 v191, v255
    s_nop 1
    s_branch L_patb20
L_pat21:
    s_nop 7
    v_mov_b32 v176, 0
    v_mov_b32 v177, 0
    v_mov_b32 v178, 0
    v_mov_b32 v179, 0
    v_mov_b32 v180, 0
    v_mov_b32 v181, 0
    v_mov_b32 v182, 0
    v_mov_b32 v183, 0
    v_mov_b32 v184, 0
    v_mov_b32 v185, 0
    v_mov_b32 v186, 0
    v_mov_b32 v187, 0
    v_mov_b32 v188, 0
    v_mov_b32 v189, 0
    v_mov_b32 v190, 0
    v_mov_b32 v191, 0
    s_nop 1
    s_branch L_patb21
L_pat22:
    s_nop 7
    v_mov_b32 v176, 0
    v_mov_b32 v177, 0
    v_mov_b32 v178, 0
    v_mov_b32 v179, 0
    v_mov_b32 v180, 0
    v_mov_b32 v181, 0
    v_mov_b32 v182, 0
    v_mov_b32 v183, 0
    v_mov_b32 v184, 0
    v_mov_b32 v185, 0
    v_mov_b32 v186, 0
    v_mov_b32 v187, 0
    v_mov_b32 v188, 0
    v_mov_b32 v189, 0
    v_mov_b32 v190, 0
    v_mov_b32 v191, 0
    s_nop 1
    s_branch L_patb22
L_pat23:
    s_nop 7
    v_mov_b32 v176, 0
    v_mov_b32 v177, 0
    v_mov_b32 v178, 0
    v_mov_b32 v179, 0
    v_mov_b32 v180, 0
    v_mov_b32 v181, 0
    v_mov_b32 v182, 0
    v_mov_b32 v183, 0
    v_mov_b32 v184, 0
    v_mov_b32 v185, 0
    v_mov_b32 v186, 0
    v_mov_b32 v187, 0
    v_mov_b32 v188, 0
    v_mov_b32 v189, 0
    v_mov_b32 v190, 0
    v_mov_b32 v191, 0
    s_nop 1
    s_branch L_patb23
L_pat24:
    s_nop 7
    v_mov_b32 v176, 0
    v_mov_b32 v177, 0
    v_mov_b32 v178, 0
    v_mov_b32 v179, 0
    v_mov_b32 v180, 0
    v_mov_b32 v181, 0
    v_mov_b32 v182, 0
    v_mov_b32 v183, 0
    v_mov_b32 v184, 0
    v_mov_b32 v185, 0
    v_mov_b32 v186, 0
    v_mov_b32 v187, 0
    v_mov_b32 v188, 0
    v_mov_b32 v189, 0
    v_mov_b32 v190, 0
    v_mov_b32 v191, 0
    s_nop 1
    s_branch L_patb24
L_pat25:
    s_nop 7
    v_mov_b32 v176, 0
    v_mov_b32 v177, 0
    v_mov_b32 v178, 0
    v_mov_b32 v179, 0
    v_mov_b32 v180, 0
    v_mov_b32 v181, 0
    v_mov_b32 v182, 0
    v_mov_b32 v183, 0
    v_mov_b32 v184, 0
    v_mov_b32 v185, 0
    v_mov_b32 v186, 0
    v_mov_b32 v187, 0
    v_mov_b32 v188, 0
    v_mov_b32 v189, 0
    v_mov_b32 v190, 0
    v_mov_b32 v191, 0
    s_nop 1
    s_branch L_patb25
L_slow26:
    s_mov_b32 s91, 0
L_spin26:
    buffer_load_dword v20, v19, s[28:31], s90 offen sc1
    s_add_u32 s91, s91, 1
    s_waitcnt vmcnt(0)
    v_cmp_ne_u32 vcc, v2, v20
    s_cmp_gt_u32 s91, 0x20000
    s_cbranch_scc1 L_back26
    s_cbranch_vccnz L_spin26
    s_branch L_back26
L_pat27:
    s_nop 7
    v_mov_b32 v176, 0
    v_mov_b32 v177, 0
    v_mov_b32 v178, 0
    v_mov_b32 v179, 0
    v_mov_b32 v180, 0
    v_mov_b32 v181, 0
    v_mov_b32 v182, 0
    v_mov_b32 v183, 0
    v_mov_b32 v184, 0
    v_mov_b32 v185, 0
    v_mov_b32 v186, 0
    v_mov_b32 v187, 0
    v_mov_b32 v188, 0
    v_mov_b32 v189, 0
    v_mov_b32 v190, 0
    v_mov_b32 v191, 0
    s_nop 1
    s_branch L_patb27
L_slow28:
    s_mov_b32 s91, 0
L_spin28:
    buffer_load_dword v20, v19, s[28:31], s90 offen sc1
    s_add_u32 s91, s91, 1
    s_waitcnt vmcnt(0)
    v_cmp_ne_u32 vcc, v2, v20
    s_cmp_gt_u32 s91, 0x20000
    s_cbranch_scc1 L_back28
    s_cbranch_vccnz L_spin28
    s_branch L_back28
L_code_end:
    s_endpgm
.section .rodata,"a"
.p2align 6
.amdhsa_kernel gated_mix__sliding_block__dense_activation_gelu__prompt_kernel
  .amdhsa_next_free_vgpr 512
  .amdhsa_next_free_sgpr 102
  .amdhsa_accum_offset 256
  .amdhsa_group_segment_fixed_size 0
  .amdhsa_kernarg_size 96
  .amdhsa_user_sgpr_count 2
  .amdhsa_user_sgpr_kernarg_segment_ptr 1
  .amdhsa_system_sgpr_workgroup_id_x 1
  .amdhsa_float_denorm_mode_32 3
.end_amdhsa_kernel
```
